```python
import torch

def _softmax(x, axis=-1):
    return torch.softmax(x, dim=axis)
def _gelu(x):
    return torch.nn.functional.gelu(x, approximate="tanh")
def _silu(x):
    return torch.nn.functional.silu(x)
def _sigmoid(x):
    return torch.sigmoid(x)
def _layernorm(x, axis=-1, eps=1e-5):
    m = x.mean(dim=axis, keepdim=True)
    v = x.var(dim=axis, keepdim=True, unbiased=False)
    return (x - m) / torch.sqrt(v + eps)
def _scatter_add(tgt, idx, src, axis=0):
    return tgt.clone().index_add_(axis, idx, src)
def _segment_sum(src, seg, n):
    out = torch.zeros((n,) + src.shape[1:], dtype=src.dtype)
    return out.index_add_(0, seg, src)
def _pad(x, pw):
    flat = tuple(v for pair in reversed(pw) for v in pair)
    return torch.nn.functional.pad(x, flat)

kernel_name = 'standalone__weight_only_int_quip_2__prompt'

def setup_inputs():

    _w = (lambda a: (lambda t: t.to(torch.bfloat16) if t.is_floating_point() else t)(torch.as_tensor(a)))
    B, S, D, F = 1, 2048, 1024, 3584
    nbits = max(2, min(4, int(8)))
    G = 64 if 64 > 0 else D
    D = (D // G) * G
    ng = D // G
    qmax = 1 << nbits
    qw = torch.randint(0, qmax, (D, F)).to(torch.int32)
    zp = torch.randint(0, qmax, (ng, F)).to(float)
    sc = torch.abs((lambda *s: torch.randn(*s, dtype=torch.bfloat16) * 0.05)(ng, F)).to(float) * 0.1 + 0.02
    return {
        "x": _w((lambda *s: torch.randn(*s, dtype=torch.bfloat16) * 0.05)(B, S, D)),
        "qw": _w(qw),
        "scales": _w(sc),
        "zeros": _w(zp),
    }

def reference(x, qw, scales, zeros):
    B, S, D = x.shape
    ng, F = scales.shape
    G = D // ng
    s = (lambda x, n, axis: torch.repeat_interleave(x, n, dim=axis))(scales, G, axis=0)
    z = (lambda x, n, axis: torch.repeat_interleave(x, n, dim=axis))(zeros, G, axis=0)
    w = ((lambda x, dt: x.to(dt))(qw, x.dtype) - z) * s
    return torch.einsum("bsd,df->bsf", x, w)
```

```asm
; @launch grid=(256,1,1) block=(512,1,1) lds=145408
.amdgcn_target "amdgcn-amd-amdhsa--gfx950"
.text
.globl standalone__weight_only_int_quip_2__prompt_kernel
.p2align 8
.type standalone__weight_only_int_quip_2__prompt_kernel,@function
standalone__weight_only_int_quip_2__prompt_kernel:
    s_cmp_ge_u32 s2, 256
    s_cbranch_scc1 L_end
    s_load_dwordx8 s[4:11], s[0:1], 0
    s_load_dwordx2 s[12:13], s[0:1], 32
    s_load_dwordx2 s[14:15], s[0:1], 48
    v_lshrrev_b32 v1, 6, v0
    v_and_b32 v0, 63, v0
    s_getpc_b64 s[40:41]
    s_and_b32 s40, s40, 0xffffff00
    s_lshr_b32 s42, s2, 3
    s_mul_i32 s42, s42, 6
    v_add_u32 v2, s42, v0
    v_lshlrev_b32 v2, 7, v2
    v_min_u32 v2, L_end-standalone__weight_only_int_quip_2__prompt_kernel, v2
    v_readfirstlane_b32 s39, v1
    v_mov_b32 v3, s41
    v_add_co_u32 v2, vcc, s40, v2
    s_nop 1
    v_addc_co_u32 v3, vcc, 0, v3, vcc
    s_cmp_lg_u32 s39, 7
    s_cbranch_scc1 L_nopf
    s_mov_b64 exec, 63
    global_load_dword v90, v[2:3], off
    s_mov_b64 exec, -1
L_nopf:
    s_and_b32 s36, s2, 7
    s_lshr_b32 s37, s2, 3
    s_lshr_b32 s38, s37, 2
    s_and_b32 s40, s36, 3
    s_lshl_b32 s40, s40, 3
    s_and_b32 s36, s36, 4
    s_and_b32 s37, s37, 3
    s_add_u32 s37, s37, s36
    s_add_u32 s36, s40, s38
    v_readfirstlane_b32 s39, v1
    v_and_b32 v1, 31, v0
    v_min_u32 v1, 27, v1
    v_lshrrev_b32 v2, 5, v0
    v_mul_u32_u24 v3, 114688, v2
    v_lshl_add_u32 v3, v1, 4, v3
    s_mul_i32 s40, s36, 448
    v_add_u32 v16, s40, v3
    v_add_u32 v17, 14336, v16
    v_add_u32 v18, 28672, v16
    v_add_u32 v19, 43008, v16
    v_add_u32 v20, 57344, v16
    v_add_u32 v21, 71680, v16
    v_add_u32 v22, 86016, v16
    v_add_u32 v23, 100352, v16
    s_mul_i32 s40, s36, 224
    v_lshlrev_b32 v3, 3, v1
    v_add_u32 v4, s40, v3
    s_lshr_b32 s40, s39, 2
    s_lshl_b32 s50, s37, 1
    s_add_u32 s50, s50, s40
    s_and_b32 s51, s39, 3
    s_lshl_b32 s48, s50, 2
    s_add_u32 s48, s48, s51
    s_mul_i32 s48, s48, 16*14336
    s_mul_i32 s49, s50, 7168
    s_mov_b32 s59, 0
    s_waitcnt lgkmcnt(0)
    s_mov_b32 s20, s6
    s_mov_b32 s21, s7
    s_mov_b32 s22, 14680064
    s_mov_b32 s23, 0x20000
    s_mov_b32 s24, s8
    s_mov_b32 s25, s9
    s_mov_b32 s26, 114688
    s_mov_b32 s27, 0x20000
    s_mov_b32 s28, s10
    s_mov_b32 s29, s11
    s_mov_b32 s30, 114688
    s_mov_b32 s31, 0x20000
    s_cmp_ge_u32 s39, 4
    s_cbranch_scc1 L_help
    buffer_load_dwordx2 v[24:25], v4, s[24:27], s49 offen
    buffer_load_dwordx2 v[26:27], v4, s[28:31], s49 offen
    buffer_load_dwordx4 v[128:131], v16, s[20:23], s48 offen
    buffer_load_dwordx4 v[132:135], v17, s[20:23], s48 offen
    buffer_load_dwordx4 v[136:139], v18, s[20:23], s48 offen
    buffer_load_dwordx4 v[140:143], v19, s[20:23], s48 offen
    buffer_load_dwordx4 v[144:147], v20, s[20:23], s48 offen
    buffer_load_dwordx4 v[148:151], v21, s[20:23], s48 offen
    buffer_load_dwordx4 v[152:155], v22, s[20:23], s48 offen
    buffer_load_dwordx4 v[156:159], v23, s[20:23], s48 offen
    s_mov_b32 s4, s14
    s_mov_b32 s5, s15
    s_mov_b32 s6, 7475200
    s_mov_b32 s7, 0x20000
    s_mov_b32 s32, s12
    s_mov_b32 s33, s13
    s_mov_b32 s34, 14680064
    s_mov_b32 s35, 0x20000
    s_lshl_b32 s44, s36, 7
    s_lshl_b32 s45, s37, 2
    s_add_u32 s44, s44, s45
    s_add_u32 s44, s44, 7471104
    v_mov_b32 v5, 0
    buffer_load_dword v110, v5, s[4:7], s44 offen sc1
    v_lshrrev_b32 v3, 3, v1
    v_lshlrev_b32 v3, 3, v3
    v_and_b32 v5, 1, v1
    v_lshl_add_u32 v3, v5, 2, v3
    v_bfe_u32 v5, v1, 1, 2
    v_add_u32 v3, v3, v5
    v_cmp_le_u32 vcc, 24, v1
    s_mul_i32 s42, s51, 3584
    s_add_u32 s40, s42, 98304
    v_cndmask_b32 v3, v3, v1, vcc
    v_and_b32 v5, 7, v3
    v_xor_b32 v5, v5, v2
    v_lshlrev_b32 v3, 7, v3
    v_add_u32 v3, s40, v3
    v_xor_b32 v6, 0, v5
    v_lshl_add_u32 v40, v6, 4, v3
    v_xor_b32 v6, 2, v5
    v_lshl_add_u32 v41, v6, 4, v3
    v_xor_b32 v6, 4, v5
    v_lshl_add_u32 v42, v6, 4, v3
    v_xor_b32 v6, 6, v5
    v_lshl_add_u32 v43, v6, 4, v3
    v_lshlrev_b32 v5, 4, v0
    v_add_u32 v68, s40, v5
    s_lshl_b32 s41, s36, 4
    s_add_u32 s41, s41, s50
    s_mul_i32 s41, s41, 14336
    s_add_u32 s41, s41, s42
    v_add_u32 v69, s41, v5
    v_add_u32 v108, 14336, v68
    v_add_u32 v109, 14336, v69
    s_waitcnt vmcnt(9)
    v_lshlrev_b32 v28, 16, v24
    v_and_b32 v29, 0xffff0000, v24
    v_lshlrev_b32 v30, 16, v25
    v_and_b32 v31, 0xffff0000, v25
    v_lshlrev_b32 v36, 16, v26
    v_and_b32 v37, 0xffff0000, v26
    v_lshlrev_b32 v38, 16, v27
    v_and_b32 v39, 0xffff0000, v27
    v_mul_f32_e64 v32, -v36, v28
    v_mul_f32_e64 v33, -v37, v29
    v_mul_f32_e64 v34, -v38, v30
    v_mul_f32_e64 v35, -v39, v31
    s_waitcnt vmcnt(1)
    v_cvt_f32_i32 v52, v128
    v_cvt_f32_i32 v53, v132
    v_cvt_f32_i32 v54, v136
    v_cvt_f32_i32 v55, v140
    v_cvt_f32_i32 v56, v144
    v_cvt_f32_i32 v57, v148
    v_cvt_f32_i32 v58, v152
    v_cvt_f32_i32 v59, v156
    v_fma_f32 v52, v52, v28, v32
    v_fma_f32 v53, v53, v28, v32
    v_fma_f32 v54, v54, v28, v32
    v_fma_f32 v55, v55, v28, v32
    v_fma_f32 v56, v56, v28, v32
    v_fma_f32 v57, v57, v28, v32
    v_fma_f32 v58, v58, v28, v32
    v_fma_f32 v59, v59, v28, v32
    v_cvt_pk_bf16_f32 v44, v52, v53
    v_cvt_pk_bf16_f32 v45, v54, v55
    v_cvt_pk_bf16_f32 v46, v56, v57
    v_cvt_pk_bf16_f32 v47, v58, v59
    ds_write_b128 v40, v[44:47]
    v_cvt_f32_i32 v60, v129
    v_cvt_f32_i32 v61, v133
    v_cvt_f32_i32 v62, v137
    v_cvt_f32_i32 v63, v141
    v_cvt_f32_i32 v64, v145
    v_cvt_f32_i32 v65, v149
    v_cvt_f32_i32 v66, v153
    v_cvt_f32_i32 v67, v157
    v_fma_f32 v60, v60, v29, v33
    v_fma_f32 v61, v61, v29, v33
    v_fma_f32 v62, v62, v29, v33
    v_fma_f32 v63, v63, v29, v33
    v_fma_f32 v64, v64, v29, v33
    v_fma_f32 v65, v65, v29, v33
    v_fma_f32 v66, v66, v29, v33
    v_fma_f32 v67, v67, v29, v33
    v_cvt_pk_bf16_f32 v48, v60, v61
    v_cvt_pk_bf16_f32 v49, v62, v63
    v_cvt_pk_bf16_f32 v50, v64, v65
    v_cvt_pk_bf16_f32 v51, v66, v67
    ds_write_b128 v41, v[48:51]
    v_cvt_f32_i32 v52, v130
    v_cvt_f32_i32 v53, v134
    v_cvt_f32_i32 v54, v138
    v_cvt_f32_i32 v55, v142
    v_cvt_f32_i32 v56, v146
    v_cvt_f32_i32 v57, v150
    v_cvt_f32_i32 v58, v154
    v_cvt_f32_i32 v59, v158
    v_fma_f32 v52, v52, v30, v34
    v_fma_f32 v53, v53, v30, v34
    v_fma_f32 v54, v54, v30, v34
    v_fma_f32 v55, v55, v30, v34
    v_fma_f32 v56, v56, v30, v34
    v_fma_f32 v57, v57, v30, v34
    v_fma_f32 v58, v58, v30, v34
    v_fma_f32 v59, v59, v30, v34
    v_cvt_pk_bf16_f32 v44, v52, v53
    v_cvt_pk_bf16_f32 v45, v54, v55
    v_cvt_pk_bf16_f32 v46, v56, v57
    v_cvt_pk_bf16_f32 v47, v58, v59
    ds_write_b128 v42, v[44:47]
    v_cvt_f32_i32 v60, v131
    v_cvt_f32_i32 v61, v135
    v_cvt_f32_i32 v62, v139
    v_cvt_f32_i32 v63, v143
    v_cvt_f32_i32 v64, v147
    v_cvt_f32_i32 v65, v151
    v_cvt_f32_i32 v66, v155
    v_cvt_f32_i32 v67, v159
    v_fma_f32 v60, v60, v31, v35
    v_fma_f32 v61, v61, v31, v35
    v_fma_f32 v62, v62, v31, v35
    v_fma_f32 v63, v63, v31, v35
    v_fma_f32 v64, v64, v31, v35
    v_fma_f32 v65, v65, v31, v35
    v_fma_f32 v66, v66, v31, v35
    v_fma_f32 v67, v67, v31, v35
    v_cvt_pk_bf16_f32 v48, v60, v61
    v_cvt_pk_bf16_f32 v49, v62, v63
    v_cvt_pk_bf16_f32 v50, v64, v65
    v_cvt_pk_bf16_f32 v51, v66, v67
    ds_write_b128 v43, v[48:51]
    s_waitcnt lgkmcnt(0)
    ds_read_b128 v[240:243], v68 offset:0
    ds_read_b128 v[244:247], v68 offset:1024
    ds_read_b128 v[248:251], v68 offset:2048
    ds_read_b128 v[252:255], v68 offset:3072
    s_waitcnt lgkmcnt(3)
    buffer_store_dwordx4 v[240:243], v69, s[4:7], 0 offen offset:0 sc1
    s_waitcnt lgkmcnt(2)
    buffer_store_dwordx4 v[244:247], v69, s[4:7], 0 offen offset:1024 sc1
    s_waitcnt lgkmcnt(1)
    buffer_store_dwordx4 v[248:251], v69, s[4:7], 0 offen offset:2048 sc1
    s_waitcnt lgkmcnt(0)
    s_mov_b32 exec_hi, 0
    buffer_store_dwordx4 v[252:255], v69, s[4:7], 0 offen offset:3072 sc1
    s_mov_b32 exec_hi, -1
    s_barrier
    v_and_b32 v1, 15, v0
    v_lshrrev_b32 v2, 4, v0
    v_lshrrev_b32 v3, 1, v1
    v_xor_b32 v3, v2, v3
    v_lshlrev_b32 v3, 4, v3
    v_lshl_add_u32 v3, v1, 7, v3
    s_lshl_b32 s40, s39, 13
    v_add_u32 v96, s40, v3
    v_xor_b32 v97, 64, v96
    v_add_u32 v98, 0x10000, v96
    v_add_u32 v99, 0x10000, v97
    v_and_b32 v3, 1, v2
    v_lshl_add_u32 v3, v1, 1, v3
    v_lshrrev_b32 v5, 2, v1
    v_xor_b32 v3, v3, v5
    v_lshlrev_b32 v3, 4, v3
    v_lshrrev_b32 v5, 1, v2
    v_mul_u32_u24 v5, 3584, v5
    v_add_u32 v5, 98304, v5
    v_add_u32 v100, v3, v5
    v_xor_b32 v3, 64, v3
    v_add_u32 v101, v3, v5
    s_mul_i32 s41, s39, 7680
    s_add_u32 s41, s41, 32768
    v_mul_u32_u24 v4, 240, v1
    v_add_u32 v4, s41, v4
    v_lshl_add_u32 v104, v2, 4, v4
    v_lshl_add_u32 v105, v2, 3, v4
    v_min_u32 v4, 55, v0
    v_mul_u32_u24 v5, 37, v4
    v_lshrrev_b32 v5, 9, v5
    v_mul_u32_u24 v3, 14, v5
    v_sub_u32 v3, v4, v3
    v_mul_u32_u24 v7, 240, v5
    v_lshl_add_u32 v7, v3, 4, v7
    v_add_u32 v106, s41, v7
    s_lshl_b32 s42, s37, 8
    s_lshl_b32 s43, s39, 6
    s_add_u32 s42, s42, s43
    s_mul_i32 s42, s42, 7168
    s_mul_i32 s43, s36, 224
    s_add_u32 s42, s42, s43
    v_mul_u32_u24 v7, 7168, v5
    v_lshl_add_u32 v7, v3, 4, v7
    v_add_u32 v107, s42, v7
    s_waitcnt vmcnt(0)
    v_readfirstlane_b32 s52, v110
    s_lshl_b32 s44, s36, 12
    s_lshl_b32 s45, s37, 7
    s_add_u32 s44, s44, s45
    s_lshl_b32 s45, s51, 1
    s_add_u32 s44, s44, s45
    s_add_u32 s44, s44, 7340032
    v_mov_b32 v5, s44
    s_xor_b32 s45, s52, 59797
    v_mov_b32 v6, s45
    s_mov_b64 exec, 1
    buffer_store_short v6, v5, s[4:7], 0 offen sc1
    s_mov_b64 exec, -1
    s_barrier
    ds_read_b128 v[40:43], v100 offset:0
    ds_read_b128 v[8:11], v96 offset:0
    ds_read_b128 v[12:15], v96 offset:2048
    ds_read_b128 v[16:19], v96 offset:4096
    ds_read_b128 v[20:23], v96 offset:6144
    ds_read_b128 v[44:47], v101 offset:512
    ds_read_b128 v[48:51], v100 offset:1024
    ds_read_b128 v[52:55], v101 offset:1536
    ds_read_b128 v[56:59], v100 offset:2048
    ds_read_b128 v[60:63], v101 offset:2560
    ds_read_b128 v[64:67], v100 offset:3072
    s_waitcnt lgkmcnt(0)
    v_mfma_f32_16x16x32_bf16 v[128:131], v[40:43], v[8:11], 0
    v_mfma_f32_16x16x32_bf16 v[132:135], v[40:43], v[12:15], 0
    ds_read_b128 v[68:71], v100 offset:7168
    v_mfma_f32_16x16x32_bf16 v[136:139], v[40:43], v[16:19], 0
    ds_read_b128 v[24:27], v97 offset:0
    v_mfma_f32_16x16x32_bf16 v[140:143], v[40:43], v[20:23], 0
    ds_read_b128 v[28:31], v97 offset:2048
    v_mfma_f32_16x16x32_bf16 v[156:159], v[44:47], v[20:23], 0
    ds_read_b128 v[32:35], v97 offset:4096
    v_mfma_f32_16x16x32_bf16 v[152:155], v[44:47], v[16:19], 0
    ds_read_b128 v[36:39], v97 offset:6144
    v_mfma_f32_16x16x32_bf16 v[148:151], v[44:47], v[12:15], 0
    ds_read_b128 v[72:75], v101 offset:7680
    v_mfma_f32_16x16x32_bf16 v[144:147], v[44:47], v[8:11], 0
    ds_read_b128 v[76:79], v100 offset:8192
    v_mfma_f32_16x16x32_bf16 v[160:163], v[48:51], v[8:11], 0
    ds_read_b128 v[80:83], v101 offset:8704
    v_mfma_f32_16x16x32_bf16 v[164:167], v[48:51], v[12:15], 0
    ds_read_b128 v[84:87], v100 offset:9216
    v_mfma_f32_16x16x32_bf16 v[168:171], v[48:51], v[16:19], 0
    ds_read_b128 v[88:91], v101 offset:9728
    v_mfma_f32_16x16x32_bf16 v[172:175], v[48:51], v[20:23], 0
    ds_read_b128 v[92:95], v100 offset:10240
    v_mfma_f32_16x16x32_bf16 v[188:191], v[52:55], v[20:23], 0
    v_mfma_f32_16x16x32_bf16 v[184:187], v[52:55], v[16:19], 0
    v_mfma_f32_16x16x32_bf16 v[180:183], v[52:55], v[12:15], 0
    v_mfma_f32_16x16x32_bf16 v[176:179], v[52:55], v[8:11], 0
    v_mfma_f32_16x16x32_bf16 v[192:195], v[56:59], v[8:11], 0
    v_mfma_f32_16x16x32_bf16 v[196:199], v[56:59], v[12:15], 0
    v_mfma_f32_16x16x32_bf16 v[200:203], v[56:59], v[16:19], 0
    v_mfma_f32_16x16x32_bf16 v[204:207], v[56:59], v[20:23], 0
    v_mfma_f32_16x16x32_bf16 v[220:223], v[60:63], v[20:23], 0
    v_mfma_f32_16x16x32_bf16 v[216:219], v[60:63], v[16:19], 0
    v_mfma_f32_16x16x32_bf16 v[212:215], v[60:63], v[12:15], 0
    v_mfma_f32_16x16x32_bf16 v[208:211], v[60:63], v[8:11], 0
    v_mfma_f32_16x16x32_bf16 v[224:227], v[64:67], v[8:11], 0
    v_mfma_f32_16x16x32_bf16 v[228:231], v[64:67], v[12:15], 0
    v_mfma_f32_16x16x32_bf16 v[232:235], v[64:67], v[16:19], 0
    v_mfma_f32_16x16x32_bf16 v[236:239], v[64:67], v[20:23], 0
    s_waitcnt lgkmcnt(0)
    v_mfma_f32_16x16x32_bf16 v[128:131], v[68:71], v[24:27], v[128:131]
    v_mfma_f32_16x16x32_bf16 v[132:135], v[68:71], v[28:31], v[132:135]
    v_mfma_f32_16x16x32_bf16 v[136:139], v[68:71], v[32:35], v[136:139]
    v_mfma_f32_16x16x32_bf16 v[140:143], v[68:71], v[36:39], v[140:143]
    v_mfma_f32_16x16x32_bf16 v[156:159], v[72:75], v[36:39], v[156:159]
    v_mfma_f32_16x16x32_bf16 v[152:155], v[72:75], v[32:35], v[152:155]
    v_mfma_f32_16x16x32_bf16 v[148:151], v[72:75], v[28:31], v[148:151]
    v_mfma_f32_16x16x32_bf16 v[144:147], v[72:75], v[24:27], v[144:147]
    v_mfma_f32_16x16x32_bf16 v[160:163], v[76:79], v[24:27], v[160:163]
    v_mfma_f32_16x16x32_bf16 v[164:167], v[76:79], v[28:31], v[164:167]
    v_mfma_f32_16x16x32_bf16 v[168:171], v[76:79], v[32:35], v[168:171]
    v_mfma_f32_16x16x32_bf16 v[172:175], v[76:79], v[36:39], v[172:175]
    v_mfma_f32_16x16x32_bf16 v[188:191], v[80:83], v[36:39], v[188:191]
    v_mfma_f32_16x16x32_bf16 v[184:187], v[80:83], v[32:35], v[184:187]
    v_mfma_f32_16x16x32_bf16 v[180:183], v[80:83], v[28:31], v[180:183]
    v_mfma_f32_16x16x32_bf16 v[176:179], v[80:83], v[24:27], v[176:179]
    v_mfma_f32_16x16x32_bf16 v[192:195], v[84:87], v[24:27], v[192:195]
    v_mfma_f32_16x16x32_bf16 v[196:199], v[84:87], v[28:31], v[196:199]
    v_mfma_f32_16x16x32_bf16 v[200:203], v[84:87], v[32:35], v[200:203]
    v_mfma_f32_16x16x32_bf16 v[204:207], v[84:87], v[36:39], v[204:207]
    v_mfma_f32_16x16x32_bf16 v[220:223], v[88:91], v[36:39], v[220:223]
    v_mfma_f32_16x16x32_bf16 v[216:219], v[88:91], v[32:35], v[216:219]
    v_mfma_f32_16x16x32_bf16 v[212:215], v[88:91], v[28:31], v[212:215]
    v_mfma_f32_16x16x32_bf16 v[208:211], v[88:91], v[24:27], v[208:211]
    s_barrier
    ds_read_b128 v[40:43], v100 offset:14336
    ds_read_b128 v[8:11], v96 offset:32768
    ds_read_b128 v[12:15], v96 offset:34816
    v_mfma_f32_16x16x32_bf16 v[224:227], v[92:95], v[24:27], v[224:227]
    ds_read_b128 v[16:19], v96 offset:36864
    ds_read_b128 v[20:23], v96 offset:38912
    ds_read_b128 v[44:47], v101 offset:14848
    v_mfma_f32_16x16x32_bf16 v[228:231], v[92:95], v[28:31], v[228:231]
    ds_read_b128 v[48:51], v100 offset:15360
    ds_read_b128 v[52:55], v101 offset:15872
    ds_read_b128 v[56:59], v100 offset:16384
    v_mfma_f32_16x16x32_bf16 v[232:235], v[92:95], v[32:35], v[232:235]
    ds_read_b128 v[60:63], v101 offset:16896
    ds_read_b128 v[64:67], v100 offset:17408
    v_mfma_f32_16x16x32_bf16 v[236:239], v[92:95], v[36:39], v[236:239]
    s_waitcnt lgkmcnt(0)
    v_mfma_f32_16x16x32_bf16 v[128:131], v[40:43], v[8:11], v[128:131]
    v_mfma_f32_16x16x32_bf16 v[132:135], v[40:43], v[12:15], v[132:135]
    ds_read_b128 v[68:71], v100 offset:21504
    v_mfma_f32_16x16x32_bf16 v[136:139], v[40:43], v[16:19], v[136:139]
    ds_read_b128 v[24:27], v97 offset:32768
    v_mfma_f32_16x16x32_bf16 v[140:143], v[40:43], v[20:23], v[140:143]
    ds_read_b128 v[28:31], v97 offset:34816
    v_mfma_f32_16x16x32_bf16 v[156:159], v[44:47], v[20:23], v[156:159]
    ds_read_b128 v[32:35], v97 offset:36864
    v_mfma_f32_16x16x32_bf16 v[152:155], v[44:47], v[16:19], v[152:155]
    ds_read_b128 v[36:39], v97 offset:38912
    v_mfma_f32_16x16x32_bf16 v[148:151], v[44:47], v[12:15], v[148:151]
    ds_read_b128 v[72:75], v101 offset:22016
    v_mfma_f32_16x16x32_bf16 v[144:147], v[44:47], v[8:11], v[144:147]
    ds_read_b128 v[76:79], v100 offset:22528
    v_mfma_f32_16x16x32_bf16 v[160:163], v[48:51], v[8:11], v[160:163]
    ds_read_b128 v[80:83], v101 offset:23040
    v_mfma_f32_16x16x32_bf16 v[164:167], v[48:51], v[12:15], v[164:167]
    ds_read_b128 v[84:87], v100 offset:23552
    v_mfma_f32_16x16x32_bf16 v[168:171], v[48:51], v[16:19], v[168:171]
    ds_read_b128 v[88:91], v101 offset:24064
    v_mfma_f32_16x16x32_bf16 v[172:175], v[48:51], v[20:23], v[172:175]
    ds_read_b128 v[92:95], v100 offset:24576
    v_mfma_f32_16x16x32_bf16 v[188:191], v[52:55], v[20:23], v[188:191]
    v_mfma_f32_16x16x32_bf16 v[184:187], v[52:55], v[16:19], v[184:187]
    ds_read_b128 v[240:243], v108 offset:0
    ds_read_b128 v[244:247], v108 offset:1024
    ds_read_b128 v[248:251], v108 offset:2048
    ds_read_b128 v[252:255], v108 offset:3072
    v_mfma_f32_16x16x32_bf16 v[180:183], v[52:55], v[12:15], v[180:183]
    v_mfma_f32_16x16x32_bf16 v[176:179], v[52:55], v[8:11], v[176:179]
    v_mfma_f32_16x16x32_bf16 v[192:195], v[56:59], v[8:11], v[192:195]
    v_mfma_f32_16x16x32_bf16 v[196:199], v[56:59], v[12:15], v[196:199]
    v_mfma_f32_16x16x32_bf16 v[200:203], v[56:59], v[16:19], v[200:203]
    v_mfma_f32_16x16x32_bf16 v[204:207], v[56:59], v[20:23], v[204:207]
    v_mfma_f32_16x16x32_bf16 v[220:223], v[60:63], v[20:23], v[220:223]
    v_mfma_f32_16x16x32_bf16 v[216:219], v[60:63], v[16:19], v[216:219]
    v_mfma_f32_16x16x32_bf16 v[212:215], v[60:63], v[12:15], v[212:215]
    v_mfma_f32_16x16x32_bf16 v[208:211], v[60:63], v[8:11], v[208:211]
    v_mfma_f32_16x16x32_bf16 v[224:227], v[64:67], v[8:11], v[224:227]
    v_mfma_f32_16x16x32_bf16 v[228:231], v[64:67], v[12:15], v[228:231]
    v_mfma_f32_16x16x32_bf16 v[232:235], v[64:67], v[16:19], v[232:235]
    v_mfma_f32_16x16x32_bf16 v[236:239], v[64:67], v[20:23], v[236:239]
    s_waitcnt lgkmcnt(0)
    s_barrier
    v_mfma_f32_16x16x32_bf16 v[128:131], v[68:71], v[24:27], v[128:131]
    v_mfma_f32_16x16x32_bf16 v[132:135], v[68:71], v[28:31], v[132:135]
    ds_read_b128 v[40:43], v100 offset:28672
    v_mfma_f32_16x16x32_bf16 v[136:139], v[68:71], v[32:35], v[136:139]
    ds_read_b128 v[8:11], v98 offset:0
    v_mfma_f32_16x16x32_bf16 v[140:143], v[68:71], v[36:39], v[140:143]
    ds_read_b128 v[12:15], v98 offset:2048
    v_mfma_f32_16x16x32_bf16 v[156:159], v[72:75], v[36:39], v[156:159]
    ds_read_b128 v[16:19], v98 offset:4096
    v_mfma_f32_16x16x32_bf16 v[152:155], v[72:75], v[32:35], v[152:155]
    ds_read_b128 v[20:23], v98 offset:6144
    v_mfma_f32_16x16x32_bf16 v[148:151], v[72:75], v[28:31], v[148:151]
    ds_read_b128 v[44:47], v101 offset:29184
    v_mfma_f32_16x16x32_bf16 v[144:147], v[72:75], v[24:27], v[144:147]
    ds_read_b128 v[48:51], v100 offset:29696
    v_mfma_f32_16x16x32_bf16 v[160:163], v[76:79], v[24:27], v[160:163]
    ds_read_b128 v[52:55], v101 offset:30208
    v_mfma_f32_16x16x32_bf16 v[164:167], v[76:79], v[28:31], v[164:167]
    ds_read_b128 v[56:59], v100 offset:30720
    v_mfma_f32_16x16x32_bf16 v[168:171], v[76:79], v[32:35], v[168:171]
    ds_read_b128 v[60:63], v101 offset:31232
    v_mfma_f32_16x16x32_bf16 v[172:175], v[76:79], v[36:39], v[172:175]
    ds_read_b128 v[64:67], v100 offset:31744
    v_mfma_f32_16x16x32_bf16 v[188:191], v[80:83], v[36:39], v[188:191]
    v_mfma_f32_16x16x32_bf16 v[184:187], v[80:83], v[32:35], v[184:187]
    v_mfma_f32_16x16x32_bf16 v[180:183], v[80:83], v[28:31], v[180:183]
    v_mfma_f32_16x16x32_bf16 v[176:179], v[80:83], v[24:27], v[176:179]
    v_mfma_f32_16x16x32_bf16 v[192:195], v[84:87], v[24:27], v[192:195]
    v_mfma_f32_16x16x32_bf16 v[196:199], v[84:87], v[28:31], v[196:199]
    v_mfma_f32_16x16x32_bf16 v[200:203], v[84:87], v[32:35], v[200:203]
    v_mfma_f32_16x16x32_bf16 v[204:207], v[84:87], v[36:39], v[204:207]
    v_mfma_f32_16x16x32_bf16 v[220:223], v[88:91], v[36:39], v[220:223]
    v_mfma_f32_16x16x32_bf16 v[216:219], v[88:91], v[32:35], v[216:219]
    v_mfma_f32_16x16x32_bf16 v[212:215], v[88:91], v[28:31], v[212:215]
    v_mfma_f32_16x16x32_bf16 v[208:211], v[88:91], v[24:27], v[208:211]
    v_mfma_f32_16x16x32_bf16 v[224:227], v[92:95], v[24:27], v[224:227]
    v_mfma_f32_16x16x32_bf16 v[228:231], v[92:95], v[28:31], v[228:231]
    v_mfma_f32_16x16x32_bf16 v[232:235], v[92:95], v[32:35], v[232:235]
    v_mfma_f32_16x16x32_bf16 v[236:239], v[92:95], v[36:39], v[236:239]
    s_waitcnt lgkmcnt(0)
    v_mfma_f32_16x16x32_bf16 v[128:131], v[40:43], v[8:11], v[128:131]
    v_mfma_f32_16x16x32_bf16 v[132:135], v[40:43], v[12:15], v[132:135]
    ds_read_b128 v[68:71], v100 offset:35840
    v_mfma_f32_16x16x32_bf16 v[136:139], v[40:43], v[16:19], v[136:139]
    ds_read_b128 v[24:27], v99 offset:0
    v_mfma_f32_16x16x32_bf16 v[140:143], v[40:43], v[20:23], v[140:143]
    ds_read_b128 v[28:31], v99 offset:2048
    v_mfma_f32_16x16x32_bf16 v[156:159], v[44:47], v[20:23], v[156:159]
    ds_read_b128 v[32:35], v99 offset:4096
    v_mfma_f32_16x16x32_bf16 v[152:155], v[44:47], v[16:19], v[152:155]
    ds_read_b128 v[36:39], v99 offset:6144
    v_mfma_f32_16x16x32_bf16 v[148:151], v[44:47], v[12:15], v[148:151]
    ds_read_b128 v[72:75], v101 offset:36352
    v_mfma_f32_16x16x32_bf16 v[144:147], v[44:47], v[8:11], v[144:147]
    ds_read_b128 v[76:79], v100 offset:36864
    v_mfma_f32_16x16x32_bf16 v[160:163], v[48:51], v[8:11], v[160:163]
    ds_read_b128 v[80:83], v101 offset:37376
    v_mfma_f32_16x16x32_bf16 v[164:167], v[48:51], v[12:15], v[164:167]
    ds_read_b128 v[84:87], v100 offset:37888
    v_mfma_f32_16x16x32_bf16 v[168:171], v[48:51], v[16:19], v[168:171]
    ds_read_b128 v[88:91], v101 offset:38400
    v_mfma_f32_16x16x32_bf16 v[172:175], v[48:51], v[20:23], v[172:175]
    ds_read_b128 v[92:95], v100 offset:38912
    v_mfma_f32_16x16x32_bf16 v[188:191], v[52:55], v[20:23], v[188:191]
    v_mfma_f32_16x16x32_bf16 v[184:187], v[52:55], v[16:19], v[184:187]
    v_mfma_f32_16x16x32_bf16 v[180:183], v[52:55], v[12:15], v[180:183]
    v_mfma_f32_16x16x32_bf16 v[176:179], v[52:55], v[8:11], v[176:179]
    v_mfma_f32_16x16x32_bf16 v[192:195], v[56:59], v[8:11], v[192:195]
    v_mfma_f32_16x16x32_bf16 v[196:199], v[56:59], v[12:15], v[196:199]
    v_mfma_f32_16x16x32_bf16 v[200:203], v[56:59], v[16:19], v[200:203]
    v_mfma_f32_16x16x32_bf16 v[204:207], v[56:59], v[20:23], v[204:207]
    v_mfma_f32_16x16x32_bf16 v[220:223], v[60:63], v[20:23], v[220:223]
    v_mfma_f32_16x16x32_bf16 v[216:219], v[60:63], v[16:19], v[216:219]
    v_mfma_f32_16x16x32_bf16 v[212:215], v[60:63], v[12:15], v[212:215]
    v_mfma_f32_16x16x32_bf16 v[208:211], v[60:63], v[8:11], v[208:211]
    v_mfma_f32_16x16x32_bf16 v[224:227], v[64:67], v[8:11], v[224:227]
    v_mfma_f32_16x16x32_bf16 v[228:231], v[64:67], v[12:15], v[228:231]
    v_mfma_f32_16x16x32_bf16 v[232:235], v[64:67], v[16:19], v[232:235]
    v_mfma_f32_16x16x32_bf16 v[236:239], v[64:67], v[20:23], v[236:239]
    s_waitcnt lgkmcnt(0)
    s_barrier
    v_mfma_f32_16x16x32_bf16 v[128:131], v[68:71], v[24:27], v[128:131]
    v_mfma_f32_16x16x32_bf16 v[132:135], v[68:71], v[28:31], v[132:135]
    ds_read_b128 v[40:43], v100 offset:0
    v_mfma_f32_16x16x32_bf16 v[136:139], v[68:71], v[32:35], v[136:139]
    ds_read_b128 v[8:11], v96 offset:0
    v_mfma_f32_16x16x32_bf16 v[140:143], v[68:71], v[36:39], v[140:143]
    ds_read_b128 v[12:15], v96 offset:2048
    v_mfma_f32_16x16x32_bf16 v[156:159], v[72:75], v[36:39], v[156:159]
    ds_read_b128 v[16:19], v96 offset:4096
    v_mfma_f32_16x16x32_bf16 v[152:155], v[72:75], v[32:35], v[152:155]
    ds_read_b128 v[20:23], v96 offset:6144
    v_mfma_f32_16x16x32_bf16 v[148:151], v[72:75], v[28:31], v[148:151]
    ds_read_b128 v[44:47], v101 offset:512
    v_mfma_f32_16x16x32_bf16 v[144:147], v[72:75], v[24:27], v[144:147]
    ds_read_b128 v[48:51], v100 offset:1024
    v_mfma_f32_16x16x32_bf16 v[160:163], v[76:79], v[24:27], v[160:163]
    ds_read_b128 v[52:55], v101 offset:1536
    v_mfma_f32_16x16x32_bf16 v[164:167], v[76:79], v[28:31], v[164:167]
    ds_read_b128 v[56:59], v100 offset:2048
    v_mfma_f32_16x16x32_bf16 v[168:171], v[76:79], v[32:35], v[168:171]
    ds_read_b128 v[60:63], v101 offset:2560
    v_mfma_f32_16x16x32_bf16 v[172:175], v[76:79], v[36:39], v[172:175]
    ds_read_b128 v[64:67], v100 offset:3072
    v_mfma_f32_16x16x32_bf16 v[188:191], v[80:83], v[36:39], v[188:191]
    v_mfma_f32_16x16x32_bf16 v[184:187], v[80:83], v[32:35], v[184:187]
    v_mfma_f32_16x16x32_bf16 v[180:183], v[80:83], v[28:31], v[180:183]
    v_mfma_f32_16x16x32_bf16 v[176:179], v[80:83], v[24:27], v[176:179]
    v_mfma_f32_16x16x32_bf16 v[192:195], v[84:87], v[24:27], v[192:195]
    v_mfma_f32_16x16x32_bf16 v[196:199], v[84:87], v[28:31], v[196:199]
    v_mfma_f32_16x16x32_bf16 v[200:203], v[84:87], v[32:35], v[200:203]
    v_mfma_f32_16x16x32_bf16 v[204:207], v[84:87], v[36:39], v[204:207]
    v_mfma_f32_16x16x32_bf16 v[220:223], v[88:91], v[36:39], v[220:223]
    v_mfma_f32_16x16x32_bf16 v[216:219], v[88:91], v[32:35], v[216:219]
    v_mfma_f32_16x16x32_bf16 v[212:215], v[88:91], v[28:31], v[212:215]
    v_mfma_f32_16x16x32_bf16 v[208:211], v[88:91], v[24:27], v[208:211]
    v_mfma_f32_16x16x32_bf16 v[224:227], v[92:95], v[24:27], v[224:227]
    v_mfma_f32_16x16x32_bf16 v[228:231], v[92:95], v[28:31], v[228:231]
    v_mfma_f32_16x16x32_bf16 v[232:235], v[92:95], v[32:35], v[232:235]
    v_mfma_f32_16x16x32_bf16 v[236:239], v[92:95], v[36:39], v[236:239]
    s_waitcnt lgkmcnt(0)
    v_mfma_f32_16x16x32_bf16 v[128:131], v[40:43], v[8:11], v[128:131]
    v_mfma_f32_16x16x32_bf16 v[132:135], v[40:43], v[12:15], v[132:135]
    ds_read_b128 v[68:71], v100 offset:7168
    v_mfma_f32_16x16x32_bf16 v[136:139], v[40:43], v[16:19], v[136:139]
    ds_read_b128 v[24:27], v97 offset:0
    v_mfma_f32_16x16x32_bf16 v[140:143], v[40:43], v[20:23], v[140:143]
    ds_read_b128 v[28:31], v97 offset:2048
    v_mfma_f32_16x16x32_bf16 v[156:159], v[44:47], v[20:23], v[156:159]
    ds_read_b128 v[32:35], v97 offset:4096
    v_mfma_f32_16x16x32_bf16 v[152:155], v[44:47], v[16:19], v[152:155]
    ds_read_b128 v[36:39], v97 offset:6144
    v_mfma_f32_16x16x32_bf16 v[148:151], v[44:47], v[12:15], v[148:151]
    ds_read_b128 v[72:75], v101 offset:7680
    v_mfma_f32_16x16x32_bf16 v[144:147], v[44:47], v[8:11], v[144:147]
    ds_read_b128 v[76:79], v100 offset:8192
    v_mfma_f32_16x16x32_bf16 v[160:163], v[48:51], v[8:11], v[160:163]
    ds_read_b128 v[80:83], v101 offset:8704
    v_mfma_f32_16x16x32_bf16 v[164:167], v[48:51], v[12:15], v[164:167]
    ds_read_b128 v[84:87], v100 offset:9216
    v_mfma_f32_16x16x32_bf16 v[168:171], v[48:51], v[16:19], v[168:171]
    ds_read_b128 v[88:91], v101 offset:9728
    v_mfma_f32_16x16x32_bf16 v[172:175], v[48:51], v[20:23], v[172:175]
    ds_read_b128 v[92:95], v100 offset:10240
    v_mfma_f32_16x16x32_bf16 v[188:191], v[52:55], v[20:23], v[188:191]
    v_mfma_f32_16x16x32_bf16 v[184:187], v[52:55], v[16:19], v[184:187]
    v_mfma_f32_16x16x32_bf16 v[180:183], v[52:55], v[12:15], v[180:183]
    v_mfma_f32_16x16x32_bf16 v[176:179], v[52:55], v[8:11], v[176:179]
    buffer_store_dwordx4 v[240:243], v109, s[4:7], 0 offen offset:0 sc1
    v_mfma_f32_16x16x32_bf16 v[192:195], v[56:59], v[8:11], v[192:195]
    v_mfma_f32_16x16x32_bf16 v[196:199], v[56:59], v[12:15], v[196:199]
    v_mfma_f32_16x16x32_bf16 v[200:203], v[56:59], v[16:19], v[200:203]
    buffer_store_dwordx4 v[244:247], v109, s[4:7], 0 offen offset:1024 sc1
    v_mfma_f32_16x16x32_bf16 v[204:207], v[56:59], v[20:23], v[204:207]
    v_mfma_f32_16x16x32_bf16 v[220:223], v[60:63], v[20:23], v[220:223]
    v_mfma_f32_16x16x32_bf16 v[216:219], v[60:63], v[16:19], v[216:219]
    buffer_store_dwordx4 v[248:251], v109, s[4:7], 0 offen offset:2048 sc1
    v_mfma_f32_16x16x32_bf16 v[212:215], v[60:63], v[12:15], v[212:215]
    v_mfma_f32_16x16x32_bf16 v[208:211], v[60:63], v[8:11], v[208:211]
    v_mfma_f32_16x16x32_bf16 v[224:227], v[64:67], v[8:11], v[224:227]
    s_mov_b32 exec_hi, 0
    buffer_store_dwordx4 v[252:255], v109, s[4:7], 0 offen offset:3072 sc1
    s_mov_b32 exec_hi, -1
    v_mfma_f32_16x16x32_bf16 v[228:231], v[64:67], v[12:15], v[228:231]
    v_mfma_f32_16x16x32_bf16 v[232:235], v[64:67], v[16:19], v[232:235]
    v_mfma_f32_16x16x32_bf16 v[236:239], v[64:67], v[20:23], v[236:239]
    s_waitcnt lgkmcnt(0)
    s_barrier
    v_mfma_f32_16x16x32_bf16 v[128:131], v[68:71], v[24:27], v[128:131]
    v_mfma_f32_16x16x32_bf16 v[132:135], v[68:71], v[28:31], v[132:135]
    ds_read_b128 v[40:43], v100 offset:14336
    v_mfma_f32_16x16x32_bf16 v[136:139], v[68:71], v[32:35], v[136:139]
    ds_read_b128 v[8:11], v96 offset:32768
    v_mfma_f32_16x16x32_bf16 v[140:143], v[68:71], v[36:39], v[140:143]
    ds_read_b128 v[12:15], v96 offset:34816
    v_mfma_f32_16x16x32_bf16 v[156:159], v[72:75], v[36:39], v[156:159]
    ds_read_b128 v[16:19], v96 offset:36864
    v_mfma_f32_16x16x32_bf16 v[152:155], v[72:75], v[32:35], v[152:155]
    ds_read_b128 v[20:23], v96 offset:38912
    v_mfma_f32_16x16x32_bf16 v[148:151], v[72:75], v[28:31], v[148:151]
    ds_read_b128 v[44:47], v101 offset:14848
    v_mfma_f32_16x16x32_bf16 v[144:147], v[72:75], v[24:27], v[144:147]
    ds_read_b128 v[48:51], v100 offset:15360
    v_mfma_f32_16x16x32_bf16 v[160:163], v[76:79], v[24:27], v[160:163]
    ds_read_b128 v[52:55], v101 offset:15872
    v_mfma_f32_16x16x32_bf16 v[164:167], v[76:79], v[28:31], v[164:167]
    ds_read_b128 v[56:59], v100 offset:16384
    v_mfma_f32_16x16x32_bf16 v[168:171], v[76:79], v[32:35], v[168:171]
    ds_read_b128 v[60:63], v101 offset:16896
    v_mfma_f32_16x16x32_bf16 v[172:175], v[76:79], v[36:39], v[172:175]
    ds_read_b128 v[64:67], v100 offset:17408
    v_mfma_f32_16x16x32_bf16 v[188:191], v[80:83], v[36:39], v[188:191]
    v_mfma_f32_16x16x32_bf16 v[184:187], v[80:83], v[32:35], v[184:187]
    v_mfma_f32_16x16x32_bf16 v[180:183], v[80:83], v[28:31], v[180:183]
    v_mfma_f32_16x16x32_bf16 v[176:179], v[80:83], v[24:27], v[176:179]
    v_mfma_f32_16x16x32_bf16 v[192:195], v[84:87], v[24:27], v[192:195]
    v_mfma_f32_16x16x32_bf16 v[196:199], v[84:87], v[28:31], v[196:199]
    v_mfma_f32_16x16x32_bf16 v[200:203], v[84:87], v[32:35], v[200:203]
    v_mfma_f32_16x16x32_bf16 v[204:207], v[84:87], v[36:39], v[204:207]
    v_mfma_f32_16x16x32_bf16 v[220:223], v[88:91], v[36:39], v[220:223]
    v_mfma_f32_16x16x32_bf16 v[216:219], v[88:91], v[32:35], v[216:219]
    v_mfma_f32_16x16x32_bf16 v[212:215], v[88:91], v[28:31], v[212:215]
    v_mfma_f32_16x16x32_bf16 v[208:211], v[88:91], v[24:27], v[208:211]
    v_mfma_f32_16x16x32_bf16 v[224:227], v[92:95], v[24:27], v[224:227]
    v_mfma_f32_16x16x32_bf16 v[228:231], v[92:95], v[28:31], v[228:231]
    v_mfma_f32_16x16x32_bf16 v[232:235], v[92:95], v[32:35], v[232:235]
    v_mfma_f32_16x16x32_bf16 v[236:239], v[92:95], v[36:39], v[236:239]
    s_waitcnt lgkmcnt(0)
    v_mfma_f32_16x16x32_bf16 v[128:131], v[40:43], v[8:11], v[128:131]
    v_mfma_f32_16x16x32_bf16 v[132:135], v[40:43], v[12:15], v[132:135]
    ds_read_b128 v[68:71], v100 offset:21504
    v_mfma_f32_16x16x32_bf16 v[136:139], v[40:43], v[16:19], v[136:139]
    ds_read_b128 v[24:27], v97 offset:32768
    v_mfma_f32_16x16x32_bf16 v[140:143], v[40:43], v[20:23], v[140:143]
    ds_read_b128 v[28:31], v97 offset:34816
    v_mfma_f32_16x16x32_bf16 v[156:159], v[44:47], v[20:23], v[156:159]
    ds_read_b128 v[32:35], v97 offset:36864
    v_mfma_f32_16x16x32_bf16 v[152:155], v[44:47], v[16:19], v[152:155]
    ds_read_b128 v[36:39], v97 offset:38912
    v_mfma_f32_16x16x32_bf16 v[148:151], v[44:47], v[12:15], v[148:151]
    ds_read_b128 v[72:75], v101 offset:22016
    v_mfma_f32_16x16x32_bf16 v[144:147], v[44:47], v[8:11], v[144:147]
    ds_read_b128 v[76:79], v100 offset:22528
    v_mfma_f32_16x16x32_bf16 v[160:163], v[48:51], v[8:11], v[160:163]
    ds_read_b128 v[80:83], v101 offset:23040
    v_mfma_f32_16x16x32_bf16 v[164:167], v[48:51], v[12:15], v[164:167]
    ds_read_b128 v[84:87], v100 offset:23552
    v_mfma_f32_16x16x32_bf16 v[168:171], v[48:51], v[16:19], v[168:171]
    ds_read_b128 v[88:91], v101 offset:24064
    v_mfma_f32_16x16x32_bf16 v[172:175], v[48:51], v[20:23], v[172:175]
    ds_read_b128 v[92:95], v100 offset:24576
    v_mfma_f32_16x16x32_bf16 v[188:191], v[52:55], v[20:23], v[188:191]
    v_mfma_f32_16x16x32_bf16 v[184:187], v[52:55], v[16:19], v[184:187]
    v_mfma_f32_16x16x32_bf16 v[180:183], v[52:55], v[12:15], v[180:183]
    v_mfma_f32_16x16x32_bf16 v[176:179], v[52:55], v[8:11], v[176:179]
    v_mfma_f32_16x16x32_bf16 v[192:195], v[56:59], v[8:11], v[192:195]
    v_mfma_f32_16x16x32_bf16 v[196:199], v[56:59], v[12:15], v[196:199]
    v_mfma_f32_16x16x32_bf16 v[200:203], v[56:59], v[16:19], v[200:203]
    v_mfma_f32_16x16x32_bf16 v[204:207], v[56:59], v[20:23], v[204:207]
    v_mfma_f32_16x16x32_bf16 v[220:223], v[60:63], v[20:23], v[220:223]
    v_mfma_f32_16x16x32_bf16 v[216:219], v[60:63], v[16:19], v[216:219]
    v_mfma_f32_16x16x32_bf16 v[212:215], v[60:63], v[12:15], v[212:215]
    v_mfma_f32_16x16x32_bf16 v[208:211], v[60:63], v[8:11], v[208:211]
    v_mfma_f32_16x16x32_bf16 v[224:227], v[64:67], v[8:11], v[224:227]
    v_mfma_f32_16x16x32_bf16 v[228:231], v[64:67], v[12:15], v[228:231]
    v_mfma_f32_16x16x32_bf16 v[232:235], v[64:67], v[16:19], v[232:235]
    v_mfma_f32_16x16x32_bf16 v[236:239], v[64:67], v[20:23], v[236:239]
    s_waitcnt lgkmcnt(0)
    s_barrier
    v_mfma_f32_16x16x32_bf16 v[128:131], v[68:71], v[24:27], v[128:131]
    v_mfma_f32_16x16x32_bf16 v[132:135], v[68:71], v[28:31], v[132:135]
    ds_read_b128 v[40:43], v100 offset:28672
    v_mfma_f32_16x16x32_bf16 v[136:139], v[68:71], v[32:35], v[136:139]
    ds_read_b128 v[8:11], v98 offset:0
    v_mfma_f32_16x16x32_bf16 v[140:143], v[68:71], v[36:39], v[140:143]
    ds_read_b128 v[12:15], v98 offset:2048
    v_mfma_f32_16x16x32_bf16 v[156:159], v[72:75], v[36:39], v[156:159]
    ds_read_b128 v[16:19], v98 offset:4096
    v_mfma_f32_16x16x32_bf16 v[152:155], v[72:75], v[32:35], v[152:155]
    ds_read_b128 v[20:23], v98 offset:6144
    v_mfma_f32_16x16x32_bf16 v[148:151], v[72:75], v[28:31], v[148:151]
    ds_read_b128 v[44:47], v101 offset:29184
    v_mfma_f32_16x16x32_bf16 v[144:147], v[72:75], v[24:27], v[144:147]
    ds_read_b128 v[48:51], v100 offset:29696
    v_mfma_f32_16x16x32_bf16 v[160:163], v[76:79], v[24:27], v[160:163]
    ds_read_b128 v[52:55], v101 offset:30208
    v_mfma_f32_16x16x32_bf16 v[164:167], v[76:79], v[28:31], v[164:167]
    ds_read_b128 v[56:59], v100 offset:30720
    v_mfma_f32_16x16x32_bf16 v[168:171], v[76:79], v[32:35], v[168:171]
    ds_read_b128 v[60:63], v101 offset:31232
    v_mfma_f32_16x16x32_bf16 v[172:175], v[76:79], v[36:39], v[172:175]
    ds_read_b128 v[64:67], v100 offset:31744
    v_mfma_f32_16x16x32_bf16 v[188:191], v[80:83], v[36:39], v[188:191]
    v_mfma_f32_16x16x32_bf16 v[184:187], v[80:83], v[32:35], v[184:187]
    v_mfma_f32_16x16x32_bf16 v[180:183], v[80:83], v[28:31], v[180:183]
    v_mfma_f32_16x16x32_bf16 v[176:179], v[80:83], v[24:27], v[176:179]
    v_mfma_f32_16x16x32_bf16 v[192:195], v[84:87], v[24:27], v[192:195]
    v_mfma_f32_16x16x32_bf16 v[196:199], v[84:87], v[28:31], v[196:199]
    v_mfma_f32_16x16x32_bf16 v[200:203], v[84:87], v[32:35], v[200:203]
    v_mfma_f32_16x16x32_bf16 v[204:207], v[84:87], v[36:39], v[204:207]
    v_mfma_f32_16x16x32_bf16 v[220:223], v[88:91], v[36:39], v[220:223]
    v_mfma_f32_16x16x32_bf16 v[216:219], v[88:91], v[32:35], v[216:219]
    v_mfma_f32_16x16x32_bf16 v[212:215], v[88:91], v[28:31], v[212:215]
    v_mfma_f32_16x16x32_bf16 v[208:211], v[88:91], v[24:27], v[208:211]
    v_mfma_f32_16x16x32_bf16 v[224:227], v[92:95], v[24:27], v[224:227]
    v_mfma_f32_16x16x32_bf16 v[228:231], v[92:95], v[28:31], v[228:231]
    v_mfma_f32_16x16x32_bf16 v[232:235], v[92:95], v[32:35], v[232:235]
    v_mfma_f32_16x16x32_bf16 v[236:239], v[92:95], v[36:39], v[236:239]
    s_waitcnt lgkmcnt(0)
    v_mfma_f32_16x16x32_bf16 v[128:131], v[40:43], v[8:11], v[128:131]
    v_mfma_f32_16x16x32_bf16 v[132:135], v[40:43], v[12:15], v[132:135]
    ds_read_b128 v[68:71], v100 offset:35840
    v_mfma_f32_16x16x32_bf16 v[136:139], v[40:43], v[16:19], v[136:139]
    ds_read_b128 v[24:27], v99 offset:0
    v_mfma_f32_16x16x32_bf16 v[140:143], v[40:43], v[20:23], v[140:143]
    ds_read_b128 v[28:31], v99 offset:2048
    v_mfma_f32_16x16x32_bf16 v[156:159], v[44:47], v[20:23], v[156:159]
    ds_read_b128 v[32:35], v99 offset:4096
    v_mfma_f32_16x16x32_bf16 v[152:155], v[44:47], v[16:19], v[152:155]
    ds_read_b128 v[36:39], v99 offset:6144
    v_mfma_f32_16x16x32_bf16 v[148:151], v[44:47], v[12:15], v[148:151]
    ds_read_b128 v[72:75], v101 offset:36352
    v_mfma_f32_16x16x32_bf16 v[144:147], v[44:47], v[8:11], v[144:147]
    ds_read_b128 v[76:79], v100 offset:36864
    v_mfma_f32_16x16x32_bf16 v[160:163], v[48:51], v[8:11], v[160:163]
    ds_read_b128 v[80:83], v101 offset:37376
    v_mfma_f32_16x16x32_bf16 v[164:167], v[48:51], v[12:15], v[164:167]
    ds_read_b128 v[84:87], v100 offset:37888
    v_mfma_f32_16x16x32_bf16 v[168:171], v[48:51], v[16:19], v[168:171]
    ds_read_b128 v[88:91], v101 offset:38400
    v_mfma_f32_16x16x32_bf16 v[172:175], v[48:51], v[20:23], v[172:175]
    ds_read_b128 v[92:95], v100 offset:38912
    v_mfma_f32_16x16x32_bf16 v[188:191], v[52:55], v[20:23], v[188:191]
    v_mfma_f32_16x16x32_bf16 v[184:187], v[52:55], v[16:19], v[184:187]
    s_waitcnt vmcnt(0)
    s_lshl_b32 s44, s36, 12
    s_lshl_b32 s45, s37, 7
    s_add_u32 s44, s44, s45
    s_lshl_b32 s45, s51, 1
    s_add_u32 s44, s44, s45
    s_add_u32 s44, s44, 7341056
    v_mov_b32 v5, s44
    s_xor_b32 s45, s52, 59797
    v_mov_b32 v6, s45
    s_mov_b64 exec, 1
    buffer_store_short v6, v5, s[4:7], 0 offen sc1
    s_mov_b64 exec, -1
    v_mfma_f32_16x16x32_bf16 v[180:183], v[52:55], v[12:15], v[180:183]
    v_mfma_f32_16x16x32_bf16 v[176:179], v[52:55], v[8:11], v[176:179]
    v_mfma_f32_16x16x32_bf16 v[192:195], v[56:59], v[8:11], v[192:195]
    v_mfma_f32_16x16x32_bf16 v[196:199], v[56:59], v[12:15], v[196:199]
    v_mfma_f32_16x16x32_bf16 v[200:203], v[56:59], v[16:19], v[200:203]
    v_mfma_f32_16x16x32_bf16 v[204:207], v[56:59], v[20:23], v[204:207]
    v_mfma_f32_16x16x32_bf16 v[220:223], v[60:63], v[20:23], v[220:223]
    v_mfma_f32_16x16x32_bf16 v[216:219], v[60:63], v[16:19], v[216:219]
    v_mfma_f32_16x16x32_bf16 v[212:215], v[60:63], v[12:15], v[212:215]
    v_mfma_f32_16x16x32_bf16 v[208:211], v[60:63], v[8:11], v[208:211]
    v_mfma_f32_16x16x32_bf16 v[224:227], v[64:67], v[8:11], v[224:227]
    v_mfma_f32_16x16x32_bf16 v[228:231], v[64:67], v[12:15], v[228:231]
    v_mfma_f32_16x16x32_bf16 v[232:235], v[64:67], v[16:19], v[232:235]
    v_mfma_f32_16x16x32_bf16 v[236:239], v[64:67], v[20:23], v[236:239]
    s_waitcnt lgkmcnt(0)
    s_barrier
    v_mfma_f32_16x16x32_bf16 v[128:131], v[68:71], v[24:27], v[128:131]
    v_mfma_f32_16x16x32_bf16 v[132:135], v[68:71], v[28:31], v[132:135]
    ds_read_b128 v[40:43], v100 offset:0
    v_mfma_f32_16x16x32_bf16 v[136:139], v[68:71], v[32:35], v[136:139]
    ds_read_b128 v[8:11], v96 offset:0
    v_mfma_f32_16x16x32_bf16 v[140:143], v[68:71], v[36:39], v[140:143]
    ds_read_b128 v[12:15], v96 offset:2048
    v_mfma_f32_16x16x32_bf16 v[156:159], v[72:75], v[36:39], v[156:159]
    ds_read_b128 v[16:19], v96 offset:4096
    v_mfma_f32_16x16x32_bf16 v[152:155], v[72:75], v[32:35], v[152:155]
    ds_read_b128 v[20:23], v96 offset:6144
    v_mfma_f32_16x16x32_bf16 v[148:151], v[72:75], v[28:31], v[148:151]
    ds_read_b128 v[44:47], v101 offset:512
    v_mfma_f32_16x16x32_bf16 v[144:147], v[72:75], v[24:27], v[144:147]
    ds_read_b128 v[48:51], v100 offset:1024
    v_mfma_f32_16x16x32_bf16 v[160:163], v[76:79], v[24:27], v[160:163]
    ds_read_b128 v[52:55], v101 offset:1536
    v_mfma_f32_16x16x32_bf16 v[164:167], v[76:79], v[28:31], v[164:167]
    ds_read_b128 v[56:59], v100 offset:2048
    v_mfma_f32_16x16x32_bf16 v[168:171], v[76:79], v[32:35], v[168:171]
    ds_read_b128 v[60:63], v101 offset:2560
    v_mfma_f32_16x16x32_bf16 v[172:175], v[76:79], v[36:39], v[172:175]
    ds_read_b128 v[64:67], v100 offset:3072
    v_mfma_f32_16x16x32_bf16 v[188:191], v[80:83], v[36:39], v[188:191]
    v_mfma_f32_16x16x32_bf16 v[184:187], v[80:83], v[32:35], v[184:187]
    v_mfma_f32_16x16x32_bf16 v[180:183], v[80:83], v[28:31], v[180:183]
    v_mfma_f32_16x16x32_bf16 v[176:179], v[80:83], v[24:27], v[176:179]
    v_mfma_f32_16x16x32_bf16 v[192:195], v[84:87], v[24:27], v[192:195]
    v_mfma_f32_16x16x32_bf16 v[196:199], v[84:87], v[28:31], v[196:199]
    v_mfma_f32_16x16x32_bf16 v[200:203], v[84:87], v[32:35], v[200:203]
    v_mfma_f32_16x16x32_bf16 v[204:207], v[84:87], v[36:39], v[204:207]
    v_mfma_f32_16x16x32_bf16 v[220:223], v[88:91], v[36:39], v[220:223]
    v_mfma_f32_16x16x32_bf16 v[216:219], v[88:91], v[32:35], v[216:219]
    v_mfma_f32_16x16x32_bf16 v[212:215], v[88:91], v[28:31], v[212:215]
    v_mfma_f32_16x16x32_bf16 v[208:211], v[88:91], v[24:27], v[208:211]
    v_mfma_f32_16x16x32_bf16 v[224:227], v[92:95], v[24:27], v[224:227]
    v_mfma_f32_16x16x32_bf16 v[228:231], v[92:95], v[28:31], v[228:231]
    v_mfma_f32_16x16x32_bf16 v[232:235], v[92:95], v[32:35], v[232:235]
    v_mfma_f32_16x16x32_bf16 v[236:239], v[92:95], v[36:39], v[236:239]
    s_waitcnt lgkmcnt(0)
    v_mfma_f32_16x16x32_bf16 v[128:131], v[40:43], v[8:11], v[128:131]
    v_mfma_f32_16x16x32_bf16 v[132:135], v[40:43], v[12:15], v[132:135]
    ds_read_b128 v[68:71], v100 offset:7168
    v_mfma_f32_16x16x32_bf16 v[136:139], v[40:43], v[16:19], v[136:139]
    ds_read_b128 v[24:27], v97 offset:0
    v_mfma_f32_16x16x32_bf16 v[140:143], v[40:43], v[20:23], v[140:143]
    ds_read_b128 v[28:31], v97 offset:2048
    v_mfma_f32_16x16x32_bf16 v[156:159], v[44:47], v[20:23], v[156:159]
    ds_read_b128 v[32:35], v97 offset:4096
    v_mfma_f32_16x16x32_bf16 v[152:155], v[44:47], v[16:19], v[152:155]
    ds_read_b128 v[36:39], v97 offset:6144
    v_mfma_f32_16x16x32_bf16 v[148:151], v[44:47], v[12:15], v[148:151]
    ds_read_b128 v[72:75], v101 offset:7680
    v_mfma_f32_16x16x32_bf16 v[144:147], v[44:47], v[8:11], v[144:147]
    ds_read_b128 v[76:79], v100 offset:8192
    v_mfma_f32_16x16x32_bf16 v[160:163], v[48:51], v[8:11], v[160:163]
    ds_read_b128 v[80:83], v101 offset:8704
    v_mfma_f32_16x16x32_bf16 v[164:167], v[48:51], v[12:15], v[164:167]
    ds_read_b128 v[84:87], v100 offset:9216
    v_mfma_f32_16x16x32_bf16 v[168:171], v[48:51], v[16:19], v[168:171]
    ds_read_b128 v[88:91], v101 offset:9728
    v_mfma_f32_16x16x32_bf16 v[172:175], v[48:51], v[20:23], v[172:175]
    ds_read_b128 v[92:95], v100 offset:10240
    v_mfma_f32_16x16x32_bf16 v[188:191], v[52:55], v[20:23], v[188:191]
    v_mfma_f32_16x16x32_bf16 v[184:187], v[52:55], v[16:19], v[184:187]
    v_mfma_f32_16x16x32_bf16 v[180:183], v[52:55], v[12:15], v[180:183]
    v_mfma_f32_16x16x32_bf16 v[176:179], v[52:55], v[8:11], v[176:179]
    v_mfma_f32_16x16x32_bf16 v[192:195], v[56:59], v[8:11], v[192:195]
    v_mfma_f32_16x16x32_bf16 v[196:199], v[56:59], v[12:15], v[196:199]
    v_mfma_f32_16x16x32_bf16 v[200:203], v[56:59], v[16:19], v[200:203]
    v_mfma_f32_16x16x32_bf16 v[204:207], v[56:59], v[20:23], v[204:207]
    v_mfma_f32_16x16x32_bf16 v[220:223], v[60:63], v[20:23], v[220:223]
    v_mfma_f32_16x16x32_bf16 v[216:219], v[60:63], v[16:19], v[216:219]
    v_mfma_f32_16x16x32_bf16 v[212:215], v[60:63], v[12:15], v[212:215]
    v_mfma_f32_16x16x32_bf16 v[208:211], v[60:63], v[8:11], v[208:211]
    v_mfma_f32_16x16x32_bf16 v[224:227], v[64:67], v[8:11], v[224:227]
    v_mfma_f32_16x16x32_bf16 v[228:231], v[64:67], v[12:15], v[228:231]
    v_mfma_f32_16x16x32_bf16 v[232:235], v[64:67], v[16:19], v[232:235]
    v_mfma_f32_16x16x32_bf16 v[236:239], v[64:67], v[20:23], v[236:239]
    s_waitcnt lgkmcnt(0)
    s_barrier
    v_mfma_f32_16x16x32_bf16 v[128:131], v[68:71], v[24:27], v[128:131]
    v_mfma_f32_16x16x32_bf16 v[132:135], v[68:71], v[28:31], v[132:135]
    ds_read_b128 v[40:43], v100 offset:14336
    v_mfma_f32_16x16x32_bf16 v[136:139], v[68:71], v[32:35], v[136:139]
    ds_read_b128 v[8:11], v96 offset:32768
    v_mfma_f32_16x16x32_bf16 v[140:143], v[68:71], v[36:39], v[140:143]
    ds_read_b128 v[12:15], v96 offset:34816
    v_mfma_f32_16x16x32_bf16 v[156:159], v[72:75], v[36:39], v[156:159]
    ds_read_b128 v[16:19], v96 offset:36864
    v_mfma_f32_16x16x32_bf16 v[152:155], v[72:75], v[32:35], v[152:155]
    ds_read_b128 v[20:23], v96 offset:38912
    v_mfma_f32_16x16x32_bf16 v[148:151], v[72:75], v[28:31], v[148:151]
    ds_read_b128 v[44:47], v101 offset:14848
    v_mfma_f32_16x16x32_bf16 v[144:147], v[72:75], v[24:27], v[144:147]
    ds_read_b128 v[48:51], v100 offset:15360
    v_mfma_f32_16x16x32_bf16 v[160:163], v[76:79], v[24:27], v[160:163]
    ds_read_b128 v[52:55], v101 offset:15872
    v_mfma_f32_16x16x32_bf16 v[164:167], v[76:79], v[28:31], v[164:167]
    ds_read_b128 v[56:59], v100 offset:16384
    v_mfma_f32_16x16x32_bf16 v[168:171], v[76:79], v[32:35], v[168:171]
    ds_read_b128 v[60:63], v101 offset:16896
    v_mfma_f32_16x16x32_bf16 v[172:175], v[76:79], v[36:39], v[172:175]
    ds_read_b128 v[64:67], v100 offset:17408
    v_mfma_f32_16x16x32_bf16 v[188:191], v[80:83], v[36:39], v[188:191]
    v_mfma_f32_16x16x32_bf16 v[184:187], v[80:83], v[32:35], v[184:187]
    v_mfma_f32_16x16x32_bf16 v[180:183], v[80:83], v[28:31], v[180:183]
    v_mfma_f32_16x16x32_bf16 v[176:179], v[80:83], v[24:27], v[176:179]
    v_mfma_f32_16x16x32_bf16 v[192:195], v[84:87], v[24:27], v[192:195]
    v_mfma_f32_16x16x32_bf16 v[196:199], v[84:87], v[28:31], v[196:199]
    v_mfma_f32_16x16x32_bf16 v[200:203], v[84:87], v[32:35], v[200:203]
    v_mfma_f32_16x16x32_bf16 v[204:207], v[84:87], v[36:39], v[204:207]
    v_mfma_f32_16x16x32_bf16 v[220:223], v[88:91], v[36:39], v[220:223]
    v_mfma_f32_16x16x32_bf16 v[216:219], v[88:91], v[32:35], v[216:219]
    v_mfma_f32_16x16x32_bf16 v[212:215], v[88:91], v[28:31], v[212:215]
    v_mfma_f32_16x16x32_bf16 v[208:211], v[88:91], v[24:27], v[208:211]
    v_mfma_f32_16x16x32_bf16 v[224:227], v[92:95], v[24:27], v[224:227]
    v_mfma_f32_16x16x32_bf16 v[228:231], v[92:95], v[28:31], v[228:231]
    v_mfma_f32_16x16x32_bf16 v[232:235], v[92:95], v[32:35], v[232:235]
    v_mfma_f32_16x16x32_bf16 v[236:239], v[92:95], v[36:39], v[236:239]
    s_waitcnt lgkmcnt(0)
    v_mfma_f32_16x16x32_bf16 v[128:131], v[40:43], v[8:11], v[128:131]
    v_mfma_f32_16x16x32_bf16 v[132:135], v[40:43], v[12:15], v[132:135]
    ds_read_b128 v[68:71], v100 offset:21504
    v_mfma_f32_16x16x32_bf16 v[136:139], v[40:43], v[16:19], v[136:139]
    ds_read_b128 v[24:27], v97 offset:32768
    v_mfma_f32_16x16x32_bf16 v[140:143], v[40:43], v[20:23], v[140:143]
    ds_read_b128 v[28:31], v97 offset:34816
    v_mfma_f32_16x16x32_bf16 v[156:159], v[44:47], v[20:23], v[156:159]
    ds_read_b128 v[32:35], v97 offset:36864
    v_mfma_f32_16x16x32_bf16 v[152:155], v[44:47], v[16:19], v[152:155]
    ds_read_b128 v[36:39], v97 offset:38912
    v_mfma_f32_16x16x32_bf16 v[148:151], v[44:47], v[12:15], v[148:151]
    ds_read_b128 v[72:75], v101 offset:22016
    v_mfma_f32_16x16x32_bf16 v[144:147], v[44:47], v[8:11], v[144:147]
    ds_read_b128 v[76:79], v100 offset:22528
    v_mfma_f32_16x16x32_bf16 v[160:163], v[48:51], v[8:11], v[160:163]
    ds_read_b128 v[80:83], v101 offset:23040
    v_mfma_f32_16x16x32_bf16 v[164:167], v[48:51], v[12:15], v[164:167]
    ds_read_b128 v[84:87], v100 offset:23552
    v_mfma_f32_16x16x32_bf16 v[168:171], v[48:51], v[16:19], v[168:171]
    ds_read_b128 v[88:91], v101 offset:24064
    v_mfma_f32_16x16x32_bf16 v[172:175], v[48:51], v[20:23], v[172:175]
    ds_read_b128 v[92:95], v100 offset:24576
    v_mfma_f32_16x16x32_bf16 v[188:191], v[52:55], v[20:23], v[188:191]
    v_mfma_f32_16x16x32_bf16 v[184:187], v[52:55], v[16:19], v[184:187]
    v_mfma_f32_16x16x32_bf16 v[180:183], v[52:55], v[12:15], v[180:183]
    v_mfma_f32_16x16x32_bf16 v[176:179], v[52:55], v[8:11], v[176:179]
    v_mfma_f32_16x16x32_bf16 v[192:195], v[56:59], v[8:11], v[192:195]
    v_mfma_f32_16x16x32_bf16 v[196:199], v[56:59], v[12:15], v[196:199]
    v_mfma_f32_16x16x32_bf16 v[200:203], v[56:59], v[16:19], v[200:203]
    v_mfma_f32_16x16x32_bf16 v[204:207], v[56:59], v[20:23], v[204:207]
    v_mfma_f32_16x16x32_bf16 v[220:223], v[60:63], v[20:23], v[220:223]
    v_mfma_f32_16x16x32_bf16 v[216:219], v[60:63], v[16:19], v[216:219]
    v_mfma_f32_16x16x32_bf16 v[212:215], v[60:63], v[12:15], v[212:215]
    v_mfma_f32_16x16x32_bf16 v[208:211], v[60:63], v[8:11], v[208:211]
    v_mfma_f32_16x16x32_bf16 v[224:227], v[64:67], v[8:11], v[224:227]
    v_mfma_f32_16x16x32_bf16 v[228:231], v[64:67], v[12:15], v[228:231]
    v_mfma_f32_16x16x32_bf16 v[232:235], v[64:67], v[16:19], v[232:235]
    v_mfma_f32_16x16x32_bf16 v[236:239], v[64:67], v[20:23], v[236:239]
    s_waitcnt lgkmcnt(0)
    s_barrier
    v_mfma_f32_16x16x32_bf16 v[128:131], v[68:71], v[24:27], v[128:131]
    v_mfma_f32_16x16x32_bf16 v[132:135], v[68:71], v[28:31], v[132:135]
    ds_read_b128 v[40:43], v100 offset:28672
    v_mfma_f32_16x16x32_bf16 v[136:139], v[68:71], v[32:35], v[136:139]
    ds_read_b128 v[8:11], v98 offset:0
    v_mfma_f32_16x16x32_bf16 v[140:143], v[68:71], v[36:39], v[140:143]
    ds_read_b128 v[12:15], v98 offset:2048
    v_mfma_f32_16x16x32_bf16 v[156:159], v[72:75], v[36:39], v[156:159]
    ds_read_b128 v[16:19], v98 offset:4096
    v_mfma_f32_16x16x32_bf16 v[152:155], v[72:75], v[32:35], v[152:155]
    ds_read_b128 v[20:23], v98 offset:6144
    v_mfma_f32_16x16x32_bf16 v[148:151], v[72:75], v[28:31], v[148:151]
    ds_read_b128 v[44:47], v101 offset:29184
    v_mfma_f32_16x16x32_bf16 v[144:147], v[72:75], v[24:27], v[144:147]
    ds_read_b128 v[48:51], v100 offset:29696
    v_mfma_f32_16x16x32_bf16 v[160:163], v[76:79], v[24:27], v[160:163]
    ds_read_b128 v[52:55], v101 offset:30208
    v_mfma_f32_16x16x32_bf16 v[164:167], v[76:79], v[28:31], v[164:167]
    ds_read_b128 v[56:59], v100 offset:30720
    v_mfma_f32_16x16x32_bf16 v[168:171], v[76:79], v[32:35], v[168:171]
    ds_read_b128 v[60:63], v101 offset:31232
    v_mfma_f32_16x16x32_bf16 v[172:175], v[76:79], v[36:39], v[172:175]
    ds_read_b128 v[64:67], v100 offset:31744
    v_mfma_f32_16x16x32_bf16 v[188:191], v[80:83], v[36:39], v[188:191]
    v_mfma_f32_16x16x32_bf16 v[184:187], v[80:83], v[32:35], v[184:187]
    v_mfma_f32_16x16x32_bf16 v[180:183], v[80:83], v[28:31], v[180:183]
    v_mfma_f32_16x16x32_bf16 v[176:179], v[80:83], v[24:27], v[176:179]
    v_mfma_f32_16x16x32_bf16 v[192:195], v[84:87], v[24:27], v[192:195]
    v_mfma_f32_16x16x32_bf16 v[196:199], v[84:87], v[28:31], v[196:199]
    v_mfma_f32_16x16x32_bf16 v[200:203], v[84:87], v[32:35], v[200:203]
    v_mfma_f32_16x16x32_bf16 v[204:207], v[84:87], v[36:39], v[204:207]
    v_mfma_f32_16x16x32_bf16 v[220:223], v[88:91], v[36:39], v[220:223]
    v_mfma_f32_16x16x32_bf16 v[216:219], v[88:91], v[32:35], v[216:219]
    v_mfma_f32_16x16x32_bf16 v[212:215], v[88:91], v[28:31], v[212:215]
    v_mfma_f32_16x16x32_bf16 v[208:211], v[88:91], v[24:27], v[208:211]
    v_mfma_f32_16x16x32_bf16 v[224:227], v[92:95], v[24:27], v[224:227]
    v_mfma_f32_16x16x32_bf16 v[228:231], v[92:95], v[28:31], v[228:231]
    v_mfma_f32_16x16x32_bf16 v[232:235], v[92:95], v[32:35], v[232:235]
    v_mfma_f32_16x16x32_bf16 v[236:239], v[92:95], v[36:39], v[236:239]
    s_waitcnt lgkmcnt(0)
    v_mfma_f32_16x16x32_bf16 v[128:131], v[40:43], v[8:11], v[128:131]
    v_mfma_f32_16x16x32_bf16 v[132:135], v[40:43], v[12:15], v[132:135]
    ds_read_b128 v[68:71], v100 offset:35840
    v_mfma_f32_16x16x32_bf16 v[136:139], v[40:43], v[16:19], v[136:139]
    ds_read_b128 v[24:27], v99 offset:0
    v_mfma_f32_16x16x32_bf16 v[140:143], v[40:43], v[20:23], v[140:143]
    ds_read_b128 v[28:31], v99 offset:2048
    v_mfma_f32_16x16x32_bf16 v[156:159], v[44:47], v[20:23], v[156:159]
    ds_read_b128 v[32:35], v99 offset:4096
    v_mfma_f32_16x16x32_bf16 v[152:155], v[44:47], v[16:19], v[152:155]
    ds_read_b128 v[36:39], v99 offset:6144
    v_mfma_f32_16x16x32_bf16 v[148:151], v[44:47], v[12:15], v[148:151]
    ds_read_b128 v[72:75], v101 offset:36352
    v_mfma_f32_16x16x32_bf16 v[144:147], v[44:47], v[8:11], v[144:147]
    ds_read_b128 v[76:79], v100 offset:36864
    v_mfma_f32_16x16x32_bf16 v[160:163], v[48:51], v[8:11], v[160:163]
    ds_read_b128 v[80:83], v101 offset:37376
    v_mfma_f32_16x16x32_bf16 v[164:167], v[48:51], v[12:15], v[164:167]
    ds_read_b128 v[84:87], v100 offset:37888
    v_mfma_f32_16x16x32_bf16 v[168:171], v[48:51], v[16:19], v[168:171]
    ds_read_b128 v[88:91], v101 offset:38400
    v_mfma_f32_16x16x32_bf16 v[172:175], v[48:51], v[20:23], v[172:175]
    ds_read_b128 v[92:95], v100 offset:38912
    v_mfma_f32_16x16x32_bf16 v[188:191], v[52:55], v[20:23], v[188:191]
    v_mfma_f32_16x16x32_bf16 v[184:187], v[52:55], v[16:19], v[184:187]
    v_mfma_f32_16x16x32_bf16 v[180:183], v[52:55], v[12:15], v[180:183]
    v_mfma_f32_16x16x32_bf16 v[176:179], v[52:55], v[8:11], v[176:179]
    v_mfma_f32_16x16x32_bf16 v[192:195], v[56:59], v[8:11], v[192:195]
    v_mfma_f32_16x16x32_bf16 v[196:199], v[56:59], v[12:15], v[196:199]
    v_mfma_f32_16x16x32_bf16 v[200:203], v[56:59], v[16:19], v[200:203]
    v_mfma_f32_16x16x32_bf16 v[204:207], v[56:59], v[20:23], v[204:207]
    v_mfma_f32_16x16x32_bf16 v[220:223], v[60:63], v[20:23], v[220:223]
    v_mfma_f32_16x16x32_bf16 v[216:219], v[60:63], v[16:19], v[216:219]
    v_mfma_f32_16x16x32_bf16 v[212:215], v[60:63], v[12:15], v[212:215]
    v_mfma_f32_16x16x32_bf16 v[208:211], v[60:63], v[8:11], v[208:211]
    v_mfma_f32_16x16x32_bf16 v[224:227], v[64:67], v[8:11], v[224:227]
    v_mfma_f32_16x16x32_bf16 v[228:231], v[64:67], v[12:15], v[228:231]
    v_mfma_f32_16x16x32_bf16 v[232:235], v[64:67], v[16:19], v[232:235]
    v_mfma_f32_16x16x32_bf16 v[236:239], v[64:67], v[20:23], v[236:239]
    s_waitcnt lgkmcnt(0)
    s_barrier
    v_mfma_f32_16x16x32_bf16 v[128:131], v[68:71], v[24:27], v[128:131]
    v_mfma_f32_16x16x32_bf16 v[132:135], v[68:71], v[28:31], v[132:135]
    ds_read_b128 v[40:43], v100 offset:0
    v_mfma_f32_16x16x32_bf16 v[136:139], v[68:71], v[32:35], v[136:139]
    ds_read_b128 v[8:11], v96 offset:0
    v_mfma_f32_16x16x32_bf16 v[140:143], v[68:71], v[36:39], v[140:143]
    ds_read_b128 v[12:15], v96 offset:2048
    v_mfma_f32_16x16x32_bf16 v[156:159], v[72:75], v[36:39], v[156:159]
    ds_read_b128 v[16:19], v96 offset:4096
    v_mfma_f32_16x16x32_bf16 v[152:155], v[72:75], v[32:35], v[152:155]
    ds_read_b128 v[20:23], v96 offset:6144
    v_mfma_f32_16x16x32_bf16 v[148:151], v[72:75], v[28:31], v[148:151]
    ds_read_b128 v[44:47], v101 offset:512
    v_mfma_f32_16x16x32_bf16 v[144:147], v[72:75], v[24:27], v[144:147]
    ds_read_b128 v[48:51], v100 offset:1024
    v_mfma_f32_16x16x32_bf16 v[160:163], v[76:79], v[24:27], v[160:163]
    ds_read_b128 v[52:55], v101 offset:1536
    v_mfma_f32_16x16x32_bf16 v[164:167], v[76:79], v[28:31], v[164:167]
    ds_read_b128 v[56:59], v100 offset:2048
    v_mfma_f32_16x16x32_bf16 v[168:171], v[76:79], v[32:35], v[168:171]
    ds_read_b128 v[60:63], v101 offset:2560
    v_mfma_f32_16x16x32_bf16 v[172:175], v[76:79], v[36:39], v[172:175]
    ds_read_b128 v[64:67], v100 offset:3072
    v_mfma_f32_16x16x32_bf16 v[188:191], v[80:83], v[36:39], v[188:191]
    v_mfma_f32_16x16x32_bf16 v[184:187], v[80:83], v[32:35], v[184:187]
    v_mfma_f32_16x16x32_bf16 v[180:183], v[80:83], v[28:31], v[180:183]
    v_mfma_f32_16x16x32_bf16 v[176:179], v[80:83], v[24:27], v[176:179]
    v_mfma_f32_16x16x32_bf16 v[192:195], v[84:87], v[24:27], v[192:195]
    v_mfma_f32_16x16x32_bf16 v[196:199], v[84:87], v[28:31], v[196:199]
    v_mfma_f32_16x16x32_bf16 v[200:203], v[84:87], v[32:35], v[200:203]
    v_mfma_f32_16x16x32_bf16 v[204:207], v[84:87], v[36:39], v[204:207]
    v_mfma_f32_16x16x32_bf16 v[220:223], v[88:91], v[36:39], v[220:223]
    v_mfma_f32_16x16x32_bf16 v[216:219], v[88:91], v[32:35], v[216:219]
    v_mfma_f32_16x16x32_bf16 v[212:215], v[88:91], v[28:31], v[212:215]
    v_mfma_f32_16x16x32_bf16 v[208:211], v[88:91], v[24:27], v[208:211]
    v_mfma_f32_16x16x32_bf16 v[224:227], v[92:95], v[24:27], v[224:227]
    v_mfma_f32_16x16x32_bf16 v[228:231], v[92:95], v[28:31], v[228:231]
    v_mfma_f32_16x16x32_bf16 v[232:235], v[92:95], v[32:35], v[232:235]
    v_mfma_f32_16x16x32_bf16 v[236:239], v[92:95], v[36:39], v[236:239]
    s_waitcnt lgkmcnt(0)
    v_mfma_f32_16x16x32_bf16 v[128:131], v[40:43], v[8:11], v[128:131]
    v_mfma_f32_16x16x32_bf16 v[132:135], v[40:43], v[12:15], v[132:135]
    ds_read_b128 v[68:71], v100 offset:7168
    v_mfma_f32_16x16x32_bf16 v[136:139], v[40:43], v[16:19], v[136:139]
    ds_read_b128 v[24:27], v97 offset:0
    v_mfma_f32_16x16x32_bf16 v[140:143], v[40:43], v[20:23], v[140:143]
    ds_read_b128 v[28:31], v97 offset:2048
    v_mfma_f32_16x16x32_bf16 v[156:159], v[44:47], v[20:23], v[156:159]
    ds_read_b128 v[32:35], v97 offset:4096
    v_mfma_f32_16x16x32_bf16 v[152:155], v[44:47], v[16:19], v[152:155]
    ds_read_b128 v[36:39], v97 offset:6144
    v_mfma_f32_16x16x32_bf16 v[148:151], v[44:47], v[12:15], v[148:151]
    ds_read_b128 v[72:75], v101 offset:7680
    v_mfma_f32_16x16x32_bf16 v[144:147], v[44:47], v[8:11], v[144:147]
    ds_read_b128 v[76:79], v100 offset:8192
    v_mfma_f32_16x16x32_bf16 v[160:163], v[48:51], v[8:11], v[160:163]
    ds_read_b128 v[80:83], v101 offset:8704
    v_mfma_f32_16x16x32_bf16 v[164:167], v[48:51], v[12:15], v[164:167]
    ds_read_b128 v[84:87], v100 offset:9216
    v_mfma_f32_16x16x32_bf16 v[168:171], v[48:51], v[16:19], v[168:171]
    ds_read_b128 v[88:91], v101 offset:9728
    v_mfma_f32_16x16x32_bf16 v[172:175], v[48:51], v[20:23], v[172:175]
    ds_read_b128 v[92:95], v100 offset:10240
    v_mfma_f32_16x16x32_bf16 v[188:191], v[52:55], v[20:23], v[188:191]
    v_mfma_f32_16x16x32_bf16 v[184:187], v[52:55], v[16:19], v[184:187]
    v_mfma_f32_16x16x32_bf16 v[180:183], v[52:55], v[12:15], v[180:183]
    v_mfma_f32_16x16x32_bf16 v[176:179], v[52:55], v[8:11], v[176:179]
    v_mfma_f32_16x16x32_bf16 v[192:195], v[56:59], v[8:11], v[192:195]
    v_mfma_f32_16x16x32_bf16 v[196:199], v[56:59], v[12:15], v[196:199]
    v_mfma_f32_16x16x32_bf16 v[200:203], v[56:59], v[16:19], v[200:203]
    v_mfma_f32_16x16x32_bf16 v[204:207], v[56:59], v[20:23], v[204:207]
    v_mfma_f32_16x16x32_bf16 v[220:223], v[60:63], v[20:23], v[220:223]
    v_mfma_f32_16x16x32_bf16 v[216:219], v[60:63], v[16:19], v[216:219]
    v_mfma_f32_16x16x32_bf16 v[212:215], v[60:63], v[12:15], v[212:215]
    v_mfma_f32_16x16x32_bf16 v[208:211], v[60:63], v[8:11], v[208:211]
    v_mfma_f32_16x16x32_bf16 v[224:227], v[64:67], v[8:11], v[224:227]
    v_mfma_f32_16x16x32_bf16 v[228:231], v[64:67], v[12:15], v[228:231]
    v_mfma_f32_16x16x32_bf16 v[232:235], v[64:67], v[16:19], v[232:235]
    v_mfma_f32_16x16x32_bf16 v[236:239], v[64:67], v[20:23], v[236:239]
    s_waitcnt lgkmcnt(0)
    s_barrier
    v_mfma_f32_16x16x32_bf16 v[128:131], v[68:71], v[24:27], v[128:131]
    v_mfma_f32_16x16x32_bf16 v[132:135], v[68:71], v[28:31], v[132:135]
    ds_read_b128 v[40:43], v100 offset:14336
    v_mfma_f32_16x16x32_bf16 v[136:139], v[68:71], v[32:35], v[136:139]
    ds_read_b128 v[8:11], v96 offset:32768
    v_mfma_f32_16x16x32_bf16 v[140:143], v[68:71], v[36:39], v[140:143]
    ds_read_b128 v[12:15], v96 offset:34816
    v_mfma_f32_16x16x32_bf16 v[156:159], v[72:75], v[36:39], v[156:159]
    ds_read_b128 v[16:19], v96 offset:36864
    v_mfma_f32_16x16x32_bf16 v[152:155], v[72:75], v[32:35], v[152:155]
    ds_read_b128 v[20:23], v96 offset:38912
    v_mfma_f32_16x16x32_bf16 v[148:151], v[72:75], v[28:31], v[148:151]
    ds_read_b128 v[44:47], v101 offset:14848
    v_mfma_f32_16x16x32_bf16 v[144:147], v[72:75], v[24:27], v[144:147]
    ds_read_b128 v[48:51], v100 offset:15360
    v_mfma_f32_16x16x32_bf16 v[160:163], v[76:79], v[24:27], v[160:163]
    ds_read_b128 v[52:55], v101 offset:15872
    v_mfma_f32_16x16x32_bf16 v[164:167], v[76:79], v[28:31], v[164:167]
    ds_read_b128 v[56:59], v100 offset:16384
    v_mfma_f32_16x16x32_bf16 v[168:171], v[76:79], v[32:35], v[168:171]
    ds_read_b128 v[60:63], v101 offset:16896
    v_mfma_f32_16x16x32_bf16 v[172:175], v[76:79], v[36:39], v[172:175]
    ds_read_b128 v[64:67], v100 offset:17408
    v_mfma_f32_16x16x32_bf16 v[188:191], v[80:83], v[36:39], v[188:191]
    v_mfma_f32_16x16x32_bf16 v[184:187], v[80:83], v[32:35], v[184:187]
    v_mfma_f32_16x16x32_bf16 v[180:183], v[80:83], v[28:31], v[180:183]
    v_mfma_f32_16x16x32_bf16 v[176:179], v[80:83], v[24:27], v[176:179]
    v_mfma_f32_16x16x32_bf16 v[192:195], v[84:87], v[24:27], v[192:195]
    v_mfma_f32_16x16x32_bf16 v[196:199], v[84:87], v[28:31], v[196:199]
    v_mfma_f32_16x16x32_bf16 v[200:203], v[84:87], v[32:35], v[200:203]
    v_mfma_f32_16x16x32_bf16 v[204:207], v[84:87], v[36:39], v[204:207]
    v_mfma_f32_16x16x32_bf16 v[220:223], v[88:91], v[36:39], v[220:223]
    v_mfma_f32_16x16x32_bf16 v[216:219], v[88:91], v[32:35], v[216:219]
    v_mfma_f32_16x16x32_bf16 v[212:215], v[88:91], v[28:31], v[212:215]
    v_mfma_f32_16x16x32_bf16 v[208:211], v[88:91], v[24:27], v[208:211]
    v_mfma_f32_16x16x32_bf16 v[224:227], v[92:95], v[24:27], v[224:227]
    v_mfma_f32_16x16x32_bf16 v[228:231], v[92:95], v[28:31], v[228:231]
    v_mfma_f32_16x16x32_bf16 v[232:235], v[92:95], v[32:35], v[232:235]
    v_mfma_f32_16x16x32_bf16 v[236:239], v[92:95], v[36:39], v[236:239]
    s_waitcnt lgkmcnt(0)
    v_mfma_f32_16x16x32_bf16 v[128:131], v[40:43], v[8:11], v[128:131]
    v_mfma_f32_16x16x32_bf16 v[132:135], v[40:43], v[12:15], v[132:135]
    ds_read_b128 v[68:71], v100 offset:21504
    v_mfma_f32_16x16x32_bf16 v[136:139], v[40:43], v[16:19], v[136:139]
    ds_read_b128 v[24:27], v97 offset:32768
    v_mfma_f32_16x16x32_bf16 v[140:143], v[40:43], v[20:23], v[140:143]
    ds_read_b128 v[28:31], v97 offset:34816
    v_mfma_f32_16x16x32_bf16 v[156:159], v[44:47], v[20:23], v[156:159]
    ds_read_b128 v[32:35], v97 offset:36864
    v_mfma_f32_16x16x32_bf16 v[152:155], v[44:47], v[16:19], v[152:155]
    ds_read_b128 v[36:39], v97 offset:38912
    v_mfma_f32_16x16x32_bf16 v[148:151], v[44:47], v[12:15], v[148:151]
    ds_read_b128 v[72:75], v101 offset:22016
    v_mfma_f32_16x16x32_bf16 v[144:147], v[44:47], v[8:11], v[144:147]
    ds_read_b128 v[76:79], v100 offset:22528
    v_mfma_f32_16x16x32_bf16 v[160:163], v[48:51], v[8:11], v[160:163]
    ds_read_b128 v[80:83], v101 offset:23040
    v_mfma_f32_16x16x32_bf16 v[164:167], v[48:51], v[12:15], v[164:167]
    ds_read_b128 v[84:87], v100 offset:23552
    v_mfma_f32_16x16x32_bf16 v[168:171], v[48:51], v[16:19], v[168:171]
    ds_read_b128 v[88:91], v101 offset:24064
    v_mfma_f32_16x16x32_bf16 v[172:175], v[48:51], v[20:23], v[172:175]
    ds_read_b128 v[92:95], v100 offset:24576
    v_mfma_f32_16x16x32_bf16 v[188:191], v[52:55], v[20:23], v[188:191]
    v_mfma_f32_16x16x32_bf16 v[184:187], v[52:55], v[16:19], v[184:187]
    v_mfma_f32_16x16x32_bf16 v[180:183], v[52:55], v[12:15], v[180:183]
    v_mfma_f32_16x16x32_bf16 v[176:179], v[52:55], v[8:11], v[176:179]
    v_mfma_f32_16x16x32_bf16 v[192:195], v[56:59], v[8:11], v[192:195]
    v_mfma_f32_16x16x32_bf16 v[196:199], v[56:59], v[12:15], v[196:199]
    v_mfma_f32_16x16x32_bf16 v[200:203], v[56:59], v[16:19], v[200:203]
    v_mfma_f32_16x16x32_bf16 v[204:207], v[56:59], v[20:23], v[204:207]
    v_mfma_f32_16x16x32_bf16 v[220:223], v[60:63], v[20:23], v[220:223]
    v_mfma_f32_16x16x32_bf16 v[216:219], v[60:63], v[16:19], v[216:219]
    v_mfma_f32_16x16x32_bf16 v[212:215], v[60:63], v[12:15], v[212:215]
    v_mfma_f32_16x16x32_bf16 v[208:211], v[60:63], v[8:11], v[208:211]
    v_mfma_f32_16x16x32_bf16 v[224:227], v[64:67], v[8:11], v[224:227]
    v_mfma_f32_16x16x32_bf16 v[228:231], v[64:67], v[12:15], v[228:231]
    v_mfma_f32_16x16x32_bf16 v[232:235], v[64:67], v[16:19], v[232:235]
    v_mfma_f32_16x16x32_bf16 v[236:239], v[64:67], v[20:23], v[236:239]
    s_waitcnt lgkmcnt(0)
    s_barrier
    v_mfma_f32_16x16x32_bf16 v[128:131], v[68:71], v[24:27], v[128:131]
    v_mfma_f32_16x16x32_bf16 v[132:135], v[68:71], v[28:31], v[132:135]
    ds_read_b128 v[40:43], v100 offset:28672
    v_mfma_f32_16x16x32_bf16 v[136:139], v[68:71], v[32:35], v[136:139]
    ds_read_b128 v[8:11], v98 offset:0
    v_mfma_f32_16x16x32_bf16 v[140:143], v[68:71], v[36:39], v[140:143]
    ds_read_b128 v[12:15], v98 offset:2048
    v_mfma_f32_16x16x32_bf16 v[156:159], v[72:75], v[36:39], v[156:159]
    ds_read_b128 v[16:19], v98 offset:4096
    v_mfma_f32_16x16x32_bf16 v[152:155], v[72:75], v[32:35], v[152:155]
    ds_read_b128 v[20:23], v98 offset:6144
    v_mfma_f32_16x16x32_bf16 v[148:151], v[72:75], v[28:31], v[148:151]
    ds_read_b128 v[44:47], v101 offset:29184
    v_mfma_f32_16x16x32_bf16 v[144:147], v[72:75], v[24:27], v[144:147]
    ds_read_b128 v[48:51], v100 offset:29696
    v_mfma_f32_16x16x32_bf16 v[160:163], v[76:79], v[24:27], v[160:163]
    ds_read_b128 v[52:55], v101 offset:30208
    v_mfma_f32_16x16x32_bf16 v[164:167], v[76:79], v[28:31], v[164:167]
    ds_read_b128 v[56:59], v100 offset:30720
    v_mfma_f32_16x16x32_bf16 v[168:171], v[76:79], v[32:35], v[168:171]
    ds_read_b128 v[60:63], v101 offset:31232
    v_mfma_f32_16x16x32_bf16 v[172:175], v[76:79], v[36:39], v[172:175]
    ds_read_b128 v[64:67], v100 offset:31744
    v_mfma_f32_16x16x32_bf16 v[188:191], v[80:83], v[36:39], v[188:191]
    v_mfma_f32_16x16x32_bf16 v[184:187], v[80:83], v[32:35], v[184:187]
    v_mfma_f32_16x16x32_bf16 v[180:183], v[80:83], v[28:31], v[180:183]
    v_mfma_f32_16x16x32_bf16 v[176:179], v[80:83], v[24:27], v[176:179]
    v_mfma_f32_16x16x32_bf16 v[192:195], v[84:87], v[24:27], v[192:195]
    v_mfma_f32_16x16x32_bf16 v[196:199], v[84:87], v[28:31], v[196:199]
    v_mfma_f32_16x16x32_bf16 v[200:203], v[84:87], v[32:35], v[200:203]
    v_mfma_f32_16x16x32_bf16 v[204:207], v[84:87], v[36:39], v[204:207]
    v_mfma_f32_16x16x32_bf16 v[220:223], v[88:91], v[36:39], v[220:223]
    v_mfma_f32_16x16x32_bf16 v[216:219], v[88:91], v[32:35], v[216:219]
    v_mfma_f32_16x16x32_bf16 v[212:215], v[88:91], v[28:31], v[212:215]
    v_mfma_f32_16x16x32_bf16 v[208:211], v[88:91], v[24:27], v[208:211]
    v_mfma_f32_16x16x32_bf16 v[224:227], v[92:95], v[24:27], v[224:227]
    v_mfma_f32_16x16x32_bf16 v[228:231], v[92:95], v[28:31], v[228:231]
    v_mfma_f32_16x16x32_bf16 v[232:235], v[92:95], v[32:35], v[232:235]
    v_mfma_f32_16x16x32_bf16 v[236:239], v[92:95], v[36:39], v[236:239]
    s_waitcnt lgkmcnt(0)
    v_mfma_f32_16x16x32_bf16 v[128:131], v[40:43], v[8:11], v[128:131]
    v_mfma_f32_16x16x32_bf16 v[132:135], v[40:43], v[12:15], v[132:135]
    ds_read_b128 v[68:71], v100 offset:35840
    v_mfma_f32_16x16x32_bf16 v[136:139], v[40:43], v[16:19], v[136:139]
    ds_read_b128 v[24:27], v99 offset:0
    v_mfma_f32_16x16x32_bf16 v[140:143], v[40:43], v[20:23], v[140:143]
    ds_read_b128 v[28:31], v99 offset:2048
    v_mfma_f32_16x16x32_bf16 v[156:159], v[44:47], v[20:23], v[156:159]
    ds_read_b128 v[32:35], v99 offset:4096
    v_mfma_f32_16x16x32_bf16 v[152:155], v[44:47], v[16:19], v[152:155]
    ds_read_b128 v[36:39], v99 offset:6144
    v_mfma_f32_16x16x32_bf16 v[148:151], v[44:47], v[12:15], v[148:151]
    ds_read_b128 v[72:75], v101 offset:36352
    v_mfma_f32_16x16x32_bf16 v[144:147], v[44:47], v[8:11], v[144:147]
    ds_read_b128 v[76:79], v100 offset:36864
    v_mfma_f32_16x16x32_bf16 v[160:163], v[48:51], v[8:11], v[160:163]
    ds_read_b128 v[80:83], v101 offset:37376
    v_mfma_f32_16x16x32_bf16 v[164:167], v[48:51], v[12:15], v[164:167]
    ds_read_b128 v[84:87], v100 offset:37888
    v_mfma_f32_16x16x32_bf16 v[168:171], v[48:51], v[16:19], v[168:171]
    ds_read_b128 v[88:91], v101 offset:38400
    v_mfma_f32_16x16x32_bf16 v[172:175], v[48:51], v[20:23], v[172:175]
    ds_read_b128 v[92:95], v100 offset:38912
    v_mfma_f32_16x16x32_bf16 v[188:191], v[52:55], v[20:23], v[188:191]
    v_mfma_f32_16x16x32_bf16 v[184:187], v[52:55], v[16:19], v[184:187]
    v_mfma_f32_16x16x32_bf16 v[180:183], v[52:55], v[12:15], v[180:183]
    v_mfma_f32_16x16x32_bf16 v[176:179], v[52:55], v[8:11], v[176:179]
    v_mfma_f32_16x16x32_bf16 v[192:195], v[56:59], v[8:11], v[192:195]
    v_mfma_f32_16x16x32_bf16 v[196:199], v[56:59], v[12:15], v[196:199]
    v_mfma_f32_16x16x32_bf16 v[200:203], v[56:59], v[16:19], v[200:203]
    v_mfma_f32_16x16x32_bf16 v[204:207], v[56:59], v[20:23], v[204:207]
    v_mfma_f32_16x16x32_bf16 v[220:223], v[60:63], v[20:23], v[220:223]
    v_mfma_f32_16x16x32_bf16 v[216:219], v[60:63], v[16:19], v[216:219]
    v_mfma_f32_16x16x32_bf16 v[212:215], v[60:63], v[12:15], v[212:215]
    v_mfma_f32_16x16x32_bf16 v[208:211], v[60:63], v[8:11], v[208:211]
    v_mfma_f32_16x16x32_bf16 v[224:227], v[64:67], v[8:11], v[224:227]
    v_mfma_f32_16x16x32_bf16 v[228:231], v[64:67], v[12:15], v[228:231]
    v_mfma_f32_16x16x32_bf16 v[232:235], v[64:67], v[16:19], v[232:235]
    v_mfma_f32_16x16x32_bf16 v[236:239], v[64:67], v[20:23], v[236:239]
    s_waitcnt lgkmcnt(0)
    s_barrier
    v_mfma_f32_16x16x32_bf16 v[128:131], v[68:71], v[24:27], v[128:131]
    v_mfma_f32_16x16x32_bf16 v[132:135], v[68:71], v[28:31], v[132:135]
    ds_read_b128 v[40:43], v100 offset:0
    v_mfma_f32_16x16x32_bf16 v[136:139], v[68:71], v[32:35], v[136:139]
    ds_read_b128 v[8:11], v96 offset:0
    v_mfma_f32_16x16x32_bf16 v[140:143], v[68:71], v[36:39], v[140:143]
    ds_read_b128 v[12:15], v96 offset:2048
    v_mfma_f32_16x16x32_bf16 v[156:159], v[72:75], v[36:39], v[156:159]
    ds_read_b128 v[16:19], v96 offset:4096
    v_mfma_f32_16x16x32_bf16 v[152:155], v[72:75], v[32:35], v[152:155]
    ds_read_b128 v[20:23], v96 offset:6144
    v_mfma_f32_16x16x32_bf16 v[148:151], v[72:75], v[28:31], v[148:151]
    ds_read_b128 v[44:47], v101 offset:512
    v_mfma_f32_16x16x32_bf16 v[144:147], v[72:75], v[24:27], v[144:147]
    ds_read_b128 v[48:51], v100 offset:1024
    v_mfma_f32_16x16x32_bf16 v[160:163], v[76:79], v[24:27], v[160:163]
    ds_read_b128 v[52:55], v101 offset:1536
    v_mfma_f32_16x16x32_bf16 v[164:167], v[76:79], v[28:31], v[164:167]
    ds_read_b128 v[56:59], v100 offset:2048
    v_mfma_f32_16x16x32_bf16 v[168:171], v[76:79], v[32:35], v[168:171]
    ds_read_b128 v[60:63], v101 offset:2560
    v_mfma_f32_16x16x32_bf16 v[172:175], v[76:79], v[36:39], v[172:175]
    ds_read_b128 v[64:67], v100 offset:3072
    v_mfma_f32_16x16x32_bf16 v[188:191], v[80:83], v[36:39], v[188:191]
    v_mfma_f32_16x16x32_bf16 v[184:187], v[80:83], v[32:35], v[184:187]
    v_mfma_f32_16x16x32_bf16 v[180:183], v[80:83], v[28:31], v[180:183]
    v_mfma_f32_16x16x32_bf16 v[176:179], v[80:83], v[24:27], v[176:179]
    v_mfma_f32_16x16x32_bf16 v[192:195], v[84:87], v[24:27], v[192:195]
    v_mfma_f32_16x16x32_bf16 v[196:199], v[84:87], v[28:31], v[196:199]
    v_mfma_f32_16x16x32_bf16 v[200:203], v[84:87], v[32:35], v[200:203]
    v_mfma_f32_16x16x32_bf16 v[204:207], v[84:87], v[36:39], v[204:207]
    v_mfma_f32_16x16x32_bf16 v[220:223], v[88:91], v[36:39], v[220:223]
    v_mfma_f32_16x16x32_bf16 v[216:219], v[88:91], v[32:35], v[216:219]
    v_mfma_f32_16x16x32_bf16 v[212:215], v[88:91], v[28:31], v[212:215]
    v_mfma_f32_16x16x32_bf16 v[208:211], v[88:91], v[24:27], v[208:211]
    v_mfma_f32_16x16x32_bf16 v[224:227], v[92:95], v[24:27], v[224:227]
    v_mfma_f32_16x16x32_bf16 v[228:231], v[92:95], v[28:31], v[228:231]
    v_mfma_f32_16x16x32_bf16 v[232:235], v[92:95], v[32:35], v[232:235]
    v_mfma_f32_16x16x32_bf16 v[236:239], v[92:95], v[36:39], v[236:239]
    s_waitcnt lgkmcnt(0)
    v_mfma_f32_16x16x32_bf16 v[128:131], v[40:43], v[8:11], v[128:131]
    v_mfma_f32_16x16x32_bf16 v[132:135], v[40:43], v[12:15], v[132:135]
    ds_read_b128 v[68:71], v100 offset:7168
    v_mfma_f32_16x16x32_bf16 v[136:139], v[40:43], v[16:19], v[136:139]
    ds_read_b128 v[24:27], v97 offset:0
    v_mfma_f32_16x16x32_bf16 v[140:143], v[40:43], v[20:23], v[140:143]
    ds_read_b128 v[28:31], v97 offset:2048
    v_mfma_f32_16x16x32_bf16 v[156:159], v[44:47], v[20:23], v[156:159]
    ds_read_b128 v[32:35], v97 offset:4096
    v_mfma_f32_16x16x32_bf16 v[152:155], v[44:47], v[16:19], v[152:155]
    ds_read_b128 v[36:39], v97 offset:6144
    v_mfma_f32_16x16x32_bf16 v[148:151], v[44:47], v[12:15], v[148:151]
    ds_read_b128 v[72:75], v101 offset:7680
    v_mfma_f32_16x16x32_bf16 v[144:147], v[44:47], v[8:11], v[144:147]
    ds_read_b128 v[76:79], v100 offset:8192
    v_mfma_f32_16x16x32_bf16 v[160:163], v[48:51], v[8:11], v[160:163]
    ds_read_b128 v[80:83], v101 offset:8704
    v_mfma_f32_16x16x32_bf16 v[164:167], v[48:51], v[12:15], v[164:167]
    ds_read_b128 v[84:87], v100 offset:9216
    v_mfma_f32_16x16x32_bf16 v[168:171], v[48:51], v[16:19], v[168:171]
    ds_read_b128 v[88:91], v101 offset:9728
    v_mfma_f32_16x16x32_bf16 v[172:175], v[48:51], v[20:23], v[172:175]
    ds_read_b128 v[92:95], v100 offset:10240
    v_mfma_f32_16x16x32_bf16 v[188:191], v[52:55], v[20:23], v[188:191]
    v_mfma_f32_16x16x32_bf16 v[184:187], v[52:55], v[16:19], v[184:187]
    v_mfma_f32_16x16x32_bf16 v[180:183], v[52:55], v[12:15], v[180:183]
    v_mfma_f32_16x16x32_bf16 v[176:179], v[52:55], v[8:11], v[176:179]
    v_mfma_f32_16x16x32_bf16 v[192:195], v[56:59], v[8:11], v[192:195]
    v_mfma_f32_16x16x32_bf16 v[196:199], v[56:59], v[12:15], v[196:199]
    v_mfma_f32_16x16x32_bf16 v[200:203], v[56:59], v[16:19], v[200:203]
    v_mfma_f32_16x16x32_bf16 v[204:207], v[56:59], v[20:23], v[204:207]
    v_mfma_f32_16x16x32_bf16 v[220:223], v[60:63], v[20:23], v[220:223]
    v_mfma_f32_16x16x32_bf16 v[216:219], v[60:63], v[16:19], v[216:219]
    v_mfma_f32_16x16x32_bf16 v[212:215], v[60:63], v[12:15], v[212:215]
    v_mfma_f32_16x16x32_bf16 v[208:211], v[60:63], v[8:11], v[208:211]
    v_mfma_f32_16x16x32_bf16 v[224:227], v[64:67], v[8:11], v[224:227]
    v_mfma_f32_16x16x32_bf16 v[228:231], v[64:67], v[12:15], v[228:231]
    v_mfma_f32_16x16x32_bf16 v[232:235], v[64:67], v[16:19], v[232:235]
    v_mfma_f32_16x16x32_bf16 v[236:239], v[64:67], v[20:23], v[236:239]
    s_waitcnt lgkmcnt(0)
    s_barrier
    v_mfma_f32_16x16x32_bf16 v[128:131], v[68:71], v[24:27], v[128:131]
    v_mfma_f32_16x16x32_bf16 v[132:135], v[68:71], v[28:31], v[132:135]
    ds_read_b128 v[40:43], v100 offset:14336
    v_mfma_f32_16x16x32_bf16 v[136:139], v[68:71], v[32:35], v[136:139]
    ds_read_b128 v[8:11], v96 offset:32768
    v_mfma_f32_16x16x32_bf16 v[140:143], v[68:71], v[36:39], v[140:143]
    ds_read_b128 v[12:15], v96 offset:34816
    v_mfma_f32_16x16x32_bf16 v[156:159], v[72:75], v[36:39], v[156:159]
    ds_read_b128 v[16:19], v96 offset:36864
    v_mfma_f32_16x16x32_bf16 v[152:155], v[72:75], v[32:35], v[152:155]
    ds_read_b128 v[20:23], v96 offset:38912
    v_mfma_f32_16x16x32_bf16 v[148:151], v[72:75], v[28:31], v[148:151]
    ds_read_b128 v[44:47], v101 offset:14848
    v_mfma_f32_16x16x32_bf16 v[144:147], v[72:75], v[24:27], v[144:147]
    ds_read_b128 v[48:51], v100 offset:15360
    v_mfma_f32_16x16x32_bf16 v[160:163], v[76:79], v[24:27], v[160:163]
    ds_read_b128 v[52:55], v101 offset:15872
    v_mfma_f32_16x16x32_bf16 v[164:167], v[76:79], v[28:31], v[164:167]
    ds_read_b128 v[56:59], v100 offset:16384
    v_mfma_f32_16x16x32_bf16 v[168:171], v[76:79], v[32:35], v[168:171]
    ds_read_b128 v[60:63], v101 offset:16896
    v_mfma_f32_16x16x32_bf16 v[172:175], v[76:79], v[36:39], v[172:175]
    ds_read_b128 v[64:67], v100 offset:17408
    v_mfma_f32_16x16x32_bf16 v[188:191], v[80:83], v[36:39], v[188:191]
    v_mfma_f32_16x16x32_bf16 v[184:187], v[80:83], v[32:35], v[184:187]
    v_mfma_f32_16x16x32_bf16 v[180:183], v[80:83], v[28:31], v[180:183]
    v_mfma_f32_16x16x32_bf16 v[176:179], v[80:83], v[24:27], v[176:179]
    v_mfma_f32_16x16x32_bf16 v[192:195], v[84:87], v[24:27], v[192:195]
    v_mfma_f32_16x16x32_bf16 v[196:199], v[84:87], v[28:31], v[196:199]
    v_mfma_f32_16x16x32_bf16 v[200:203], v[84:87], v[32:35], v[200:203]
    v_mfma_f32_16x16x32_bf16 v[204:207], v[84:87], v[36:39], v[204:207]
    v_mfma_f32_16x16x32_bf16 v[220:223], v[88:91], v[36:39], v[220:223]
    v_mfma_f32_16x16x32_bf16 v[216:219], v[88:91], v[32:35], v[216:219]
    v_mfma_f32_16x16x32_bf16 v[212:215], v[88:91], v[28:31], v[212:215]
    v_mfma_f32_16x16x32_bf16 v[208:211], v[88:91], v[24:27], v[208:211]
    v_mfma_f32_16x16x32_bf16 v[224:227], v[92:95], v[24:27], v[224:227]
    v_mfma_f32_16x16x32_bf16 v[228:231], v[92:95], v[28:31], v[228:231]
    v_mfma_f32_16x16x32_bf16 v[232:235], v[92:95], v[32:35], v[232:235]
    v_mfma_f32_16x16x32_bf16 v[236:239], v[92:95], v[36:39], v[236:239]
    s_waitcnt lgkmcnt(0)
    v_mfma_f32_16x16x32_bf16 v[128:131], v[40:43], v[8:11], v[128:131]
    v_mfma_f32_16x16x32_bf16 v[132:135], v[40:43], v[12:15], v[132:135]
    ds_read_b128 v[68:71], v100 offset:21504
    v_mfma_f32_16x16x32_bf16 v[136:139], v[40:43], v[16:19], v[136:139]
    ds_read_b128 v[24:27], v97 offset:32768
    v_mfma_f32_16x16x32_bf16 v[140:143], v[40:43], v[20:23], v[140:143]
    ds_read_b128 v[28:31], v97 offset:34816
    v_mfma_f32_16x16x32_bf16 v[156:159], v[44:47], v[20:23], v[156:159]
    ds_read_b128 v[32:35], v97 offset:36864
    v_mfma_f32_16x16x32_bf16 v[152:155], v[44:47], v[16:19], v[152:155]
    ds_read_b128 v[36:39], v97 offset:38912
    v_mfma_f32_16x16x32_bf16 v[148:151], v[44:47], v[12:15], v[148:151]
    ds_read_b128 v[72:75], v101 offset:22016
    v_mfma_f32_16x16x32_bf16 v[144:147], v[44:47], v[8:11], v[144:147]
    ds_read_b128 v[76:79], v100 offset:22528
    v_mfma_f32_16x16x32_bf16 v[160:163], v[48:51], v[8:11], v[160:163]
    ds_read_b128 v[80:83], v101 offset:23040
    v_mfma_f32_16x16x32_bf16 v[164:167], v[48:51], v[12:15], v[164:167]
    ds_read_b128 v[84:87], v100 offset:23552
    v_mfma_f32_16x16x32_bf16 v[168:171], v[48:51], v[16:19], v[168:171]
    ds_read_b128 v[88:91], v101 offset:24064
    v_mfma_f32_16x16x32_bf16 v[172:175], v[48:51], v[20:23], v[172:175]
    ds_read_b128 v[92:95], v100 offset:24576
    v_mfma_f32_16x16x32_bf16 v[188:191], v[52:55], v[20:23], v[188:191]
    v_mfma_f32_16x16x32_bf16 v[184:187], v[52:55], v[16:19], v[184:187]
    v_mfma_f32_16x16x32_bf16 v[180:183], v[52:55], v[12:15], v[180:183]
    v_mfma_f32_16x16x32_bf16 v[176:179], v[52:55], v[8:11], v[176:179]
    v_mfma_f32_16x16x32_bf16 v[192:195], v[56:59], v[8:11], v[192:195]
    v_mfma_f32_16x16x32_bf16 v[196:199], v[56:59], v[12:15], v[196:199]
    v_mfma_f32_16x16x32_bf16 v[200:203], v[56:59], v[16:19], v[200:203]
    v_mfma_f32_16x16x32_bf16 v[204:207], v[56:59], v[20:23], v[204:207]
    v_mfma_f32_16x16x32_bf16 v[220:223], v[60:63], v[20:23], v[220:223]
    v_mfma_f32_16x16x32_bf16 v[216:219], v[60:63], v[16:19], v[216:219]
    v_mfma_f32_16x16x32_bf16 v[212:215], v[60:63], v[12:15], v[212:215]
    v_mfma_f32_16x16x32_bf16 v[208:211], v[60:63], v[8:11], v[208:211]
    v_mfma_f32_16x16x32_bf16 v[224:227], v[64:67], v[8:11], v[224:227]
    v_mfma_f32_16x16x32_bf16 v[228:231], v[64:67], v[12:15], v[228:231]
    v_mfma_f32_16x16x32_bf16 v[232:235], v[64:67], v[16:19], v[232:235]
    v_mfma_f32_16x16x32_bf16 v[236:239], v[64:67], v[20:23], v[236:239]
    s_waitcnt lgkmcnt(0)
    s_barrier
    v_mfma_f32_16x16x32_bf16 v[128:131], v[68:71], v[24:27], v[128:131]
    v_mfma_f32_16x16x32_bf16 v[132:135], v[68:71], v[28:31], v[132:135]
    ds_read_b128 v[8:11], v98 offset:0
    v_mfma_f32_16x16x32_bf16 v[136:139], v[68:71], v[32:35], v[136:139]
    ds_read_b128 v[12:15], v98 offset:2048
    v_mfma_f32_16x16x32_bf16 v[140:143], v[68:71], v[36:39], v[140:143]
    ds_read_b128 v[40:43], v100 offset:28672
    v_mfma_f32_16x16x32_bf16 v[156:159], v[72:75], v[36:39], v[156:159]
    ds_read_b128 v[44:47], v101 offset:29184
    v_mfma_f32_16x16x32_bf16 v[152:155], v[72:75], v[32:35], v[152:155]
    ds_read_b128 v[48:51], v100 offset:29696
    v_mfma_f32_16x16x32_bf16 v[148:151], v[72:75], v[28:31], v[148:151]
    ds_read_b128 v[52:55], v101 offset:30208
    v_mfma_f32_16x16x32_bf16 v[144:147], v[72:75], v[24:27], v[144:147]
    ds_read_b128 v[56:59], v100 offset:30720
    v_mfma_f32_16x16x32_bf16 v[160:163], v[76:79], v[24:27], v[160:163]
    ds_read_b128 v[60:63], v101 offset:31232
    v_mfma_f32_16x16x32_bf16 v[164:167], v[76:79], v[28:31], v[164:167]
    ds_read_b128 v[64:67], v100 offset:31744
    v_mfma_f32_16x16x32_bf16 v[168:171], v[76:79], v[32:35], v[168:171]
    v_mfma_f32_16x16x32_bf16 v[172:175], v[76:79], v[36:39], v[172:175]
    v_mfma_f32_16x16x32_bf16 v[188:191], v[80:83], v[36:39], v[188:191]
    v_mfma_f32_16x16x32_bf16 v[184:187], v[80:83], v[32:35], v[184:187]
    v_mfma_f32_16x16x32_bf16 v[180:183], v[80:83], v[28:31], v[180:183]
    v_mfma_f32_16x16x32_bf16 v[176:179], v[80:83], v[24:27], v[176:179]
    v_mfma_f32_16x16x32_bf16 v[192:195], v[84:87], v[24:27], v[192:195]
    v_mfma_f32_16x16x32_bf16 v[196:199], v[84:87], v[28:31], v[196:199]
    v_mfma_f32_16x16x32_bf16 v[200:203], v[84:87], v[32:35], v[200:203]
    v_mfma_f32_16x16x32_bf16 v[204:207], v[84:87], v[36:39], v[204:207]
    v_mfma_f32_16x16x32_bf16 v[220:223], v[88:91], v[36:39], v[220:223]
    v_mfma_f32_16x16x32_bf16 v[216:219], v[88:91], v[32:35], v[216:219]
    v_mfma_f32_16x16x32_bf16 v[212:215], v[88:91], v[28:31], v[212:215]
    v_mfma_f32_16x16x32_bf16 v[208:211], v[88:91], v[24:27], v[208:211]
    v_mfma_f32_16x16x32_bf16 v[224:227], v[92:95], v[24:27], v[224:227]
    v_mfma_f32_16x16x32_bf16 v[228:231], v[92:95], v[28:31], v[228:231]
    v_mfma_f32_16x16x32_bf16 v[232:235], v[92:95], v[32:35], v[232:235]
    v_mfma_f32_16x16x32_bf16 v[236:239], v[92:95], v[36:39], v[236:239]
    s_waitcnt lgkmcnt(6)
    v_mfma_f32_16x16x32_bf16 v[128:131], v[40:43], v[8:11], v[128:131]
    ds_read_b128 v[24:27], v99 offset:0
    v_mfma_f32_16x16x32_bf16 v[132:135], v[40:43], v[12:15], v[132:135]
    ds_read_b128 v[28:31], v99 offset:2048
    s_waitcnt lgkmcnt(7)
    v_mfma_f32_16x16x32_bf16 v[148:151], v[44:47], v[12:15], v[148:151]
    ds_read_b128 v[68:71], v100 offset:35840
    v_mfma_f32_16x16x32_bf16 v[144:147], v[44:47], v[8:11], v[144:147]
    ds_read_b128 v[72:75], v101 offset:36352
    s_waitcnt lgkmcnt(8)
    v_mfma_f32_16x16x32_bf16 v[160:163], v[48:51], v[8:11], v[160:163]
    ds_read_b128 v[76:79], v100 offset:36864
    v_mfma_f32_16x16x32_bf16 v[164:167], v[48:51], v[12:15], v[164:167]
    ds_read_b128 v[80:83], v101 offset:37376
    s_waitcnt lgkmcnt(9)
    v_mfma_f32_16x16x32_bf16 v[180:183], v[52:55], v[12:15], v[180:183]
    ds_read_b128 v[84:87], v100 offset:37888
    v_mfma_f32_16x16x32_bf16 v[176:179], v[52:55], v[8:11], v[176:179]
    ds_read_b128 v[88:91], v101 offset:38400
    s_waitcnt lgkmcnt(10)
    v_mfma_f32_16x16x32_bf16 v[192:195], v[56:59], v[8:11], v[192:195]
    ds_read_b128 v[92:95], v100 offset:38912
    v_mfma_f32_16x16x32_bf16 v[196:199], v[56:59], v[12:15], v[196:199]
    s_waitcnt lgkmcnt(10)
    v_mfma_f32_16x16x32_bf16 v[212:215], v[60:63], v[12:15], v[212:215]
    v_mfma_f32_16x16x32_bf16 v[208:211], v[60:63], v[8:11], v[208:211]
    s_waitcnt lgkmcnt(9)
    v_mfma_f32_16x16x32_bf16 v[224:227], v[64:67], v[8:11], v[224:227]
    v_mfma_f32_16x16x32_bf16 v[228:231], v[64:67], v[12:15], v[228:231]
    s_barrier
    s_waitcnt lgkmcnt(6)
    v_mfma_f32_16x16x32_bf16 v[128:131], v[68:71], v[24:27], v[128:131]
    ds_read_b128 v[8:11], v96 offset:0
    v_mfma_f32_16x16x32_bf16 v[132:135], v[68:71], v[28:31], v[132:135]
    ds_read_b128 v[12:15], v96 offset:2048
    s_waitcnt lgkmcnt(7)
    v_mfma_f32_16x16x32_bf16 v[148:151], v[72:75], v[28:31], v[148:151]
    ds_read_b128 v[40:43], v100 offset:0
    v_mfma_f32_16x16x32_bf16 v[144:147], v[72:75], v[24:27], v[144:147]
    ds_read_b128 v[44:47], v101 offset:512
    s_waitcnt lgkmcnt(8)
    v_mfma_f32_16x16x32_bf16 v[160:163], v[76:79], v[24:27], v[160:163]
    ds_read_b128 v[48:51], v100 offset:1024
    v_mfma_f32_16x16x32_bf16 v[164:167], v[76:79], v[28:31], v[164:167]
    ds_read_b128 v[52:55], v101 offset:1536
    s_waitcnt lgkmcnt(9)
    v_mfma_f32_16x16x32_bf16 v[180:183], v[80:83], v[28:31], v[180:183]
    ds_read_b128 v[56:59], v100 offset:2048
    v_mfma_f32_16x16x32_bf16 v[176:179], v[80:83], v[24:27], v[176:179]
    ds_read_b128 v[60:63], v101 offset:2560
    s_waitcnt lgkmcnt(10)
    v_mfma_f32_16x16x32_bf16 v[192:195], v[84:87], v[24:27], v[192:195]
    ds_read_b128 v[64:67], v100 offset:3072
    v_mfma_f32_16x16x32_bf16 v[196:199], v[84:87], v[28:31], v[196:199]
    s_waitcnt lgkmcnt(10)
    v_mfma_f32_16x16x32_bf16 v[212:215], v[88:91], v[28:31], v[212:215]
    v_mfma_f32_16x16x32_bf16 v[208:211], v[88:91], v[24:27], v[208:211]
    s_waitcnt lgkmcnt(9)
    v_mfma_f32_16x16x32_bf16 v[224:227], v[92:95], v[24:27], v[224:227]
    v_mfma_f32_16x16x32_bf16 v[228:231], v[92:95], v[28:31], v[228:231]
    s_waitcnt lgkmcnt(6)
    v_mfma_f32_16x16x32_bf16 v[128:131], v[40:43], v[8:11], v[128:131]
    ds_read_b128 v[24:27], v97 offset:0
    v_mfma_f32_16x16x32_bf16 v[132:135], v[40:43], v[12:15], v[132:135]
    ds_read_b128 v[28:31], v97 offset:2048
    s_waitcnt lgkmcnt(7)
    v_mfma_f32_16x16x32_bf16 v[148:151], v[44:47], v[12:15], v[148:151]
    ds_read_b128 v[68:71], v100 offset:7168
    v_mfma_f32_16x16x32_bf16 v[144:147], v[44:47], v[8:11], v[144:147]
    ds_read_b128 v[72:75], v101 offset:7680
    s_waitcnt lgkmcnt(8)
    v_mfma_f32_16x16x32_bf16 v[160:163], v[48:51], v[8:11], v[160:163]
    ds_read_b128 v[76:79], v100 offset:8192
    v_mfma_f32_16x16x32_bf16 v[164:167], v[48:51], v[12:15], v[164:167]
    ds_read_b128 v[80:83], v101 offset:8704
    s_waitcnt lgkmcnt(9)
    v_mfma_f32_16x16x32_bf16 v[180:183], v[52:55], v[12:15], v[180:183]
    ds_read_b128 v[84:87], v100 offset:9216
    v_mfma_f32_16x16x32_bf16 v[176:179], v[52:55], v[8:11], v[176:179]
    ds_read_b128 v[88:91], v101 offset:9728
    s_waitcnt lgkmcnt(10)
    v_mfma_f32_16x16x32_bf16 v[192:195], v[56:59], v[8:11], v[192:195]
    ds_read_b128 v[92:95], v100 offset:10240
    v_mfma_f32_16x16x32_bf16 v[196:199], v[56:59], v[12:15], v[196:199]
    s_waitcnt lgkmcnt(10)
    v_mfma_f32_16x16x32_bf16 v[212:215], v[60:63], v[12:15], v[212:215]
    v_mfma_f32_16x16x32_bf16 v[208:211], v[60:63], v[8:11], v[208:211]
    s_waitcnt lgkmcnt(9)
    v_mfma_f32_16x16x32_bf16 v[224:227], v[64:67], v[8:11], v[224:227]
    v_mfma_f32_16x16x32_bf16 v[228:231], v[64:67], v[12:15], v[228:231]
    s_waitcnt lgkmcnt(6)
    v_mfma_f32_16x16x32_bf16 v[128:131], v[68:71], v[24:27], v[128:131]
    ds_read_b128 v[8:11], v98 offset:4096
    v_mfma_f32_16x16x32_bf16 v[132:135], v[68:71], v[28:31], v[132:135]
    ds_read_b128 v[12:15], v98 offset:6144
    s_waitcnt lgkmcnt(7)
    v_mfma_f32_16x16x32_bf16 v[148:151], v[72:75], v[28:31], v[148:151]
    ds_read_b128 v[40:43], v100 offset:28672
    v_mfma_f32_16x16x32_bf16 v[144:147], v[72:75], v[24:27], v[144:147]
    ds_read_b128 v[44:47], v101 offset:29184
    s_waitcnt lgkmcnt(8)
    v_mfma_f32_16x16x32_bf16 v[160:163], v[76:79], v[24:27], v[160:163]
    ds_read_b128 v[48:51], v100 offset:29696
    v_mfma_f32_16x16x32_bf16 v[164:167], v[76:79], v[28:31], v[164:167]
    ds_read_b128 v[52:55], v101 offset:30208
    s_waitcnt lgkmcnt(9)
    v_mfma_f32_16x16x32_bf16 v[180:183], v[80:83], v[28:31], v[180:183]
    ds_read_b128 v[56:59], v100 offset:30720
    v_mfma_f32_16x16x32_bf16 v[176:179], v[80:83], v[24:27], v[176:179]
    ds_read_b128 v[60:63], v101 offset:31232
    s_waitcnt lgkmcnt(10)
    v_mfma_f32_16x16x32_bf16 v[192:195], v[84:87], v[24:27], v[192:195]
    ds_read_b128 v[64:67], v100 offset:31744
    v_mfma_f32_16x16x32_bf16 v[196:199], v[84:87], v[28:31], v[196:199]
    s_waitcnt lgkmcnt(10)
    v_mfma_f32_16x16x32_bf16 v[212:215], v[88:91], v[28:31], v[212:215]
    v_mfma_f32_16x16x32_bf16 v[208:211], v[88:91], v[24:27], v[208:211]
    s_waitcnt lgkmcnt(9)
    v_mfma_f32_16x16x32_bf16 v[224:227], v[92:95], v[24:27], v[224:227]
    v_mfma_f32_16x16x32_bf16 v[228:231], v[92:95], v[28:31], v[228:231]
    s_waitcnt lgkmcnt(6)
    v_mfma_f32_16x16x32_bf16 v[136:139], v[40:43], v[8:11], v[136:139]
    ds_read_b128 v[24:27], v99 offset:4096
    v_mfma_f32_16x16x32_bf16 v[140:143], v[40:43], v[12:15], v[140:143]
    ds_read_b128 v[28:31], v99 offset:6144
    s_waitcnt lgkmcnt(7)
    v_mfma_f32_16x16x32_bf16 v[156:159], v[44:47], v[12:15], v[156:159]
    ds_read_b128 v[68:71], v100 offset:35840
    v_cvt_pk_bf16_f32 v16, v128, v129
    v_cvt_pk_bf16_f32 v17, v130, v131
    v_mfma_f32_16x16x32_bf16 v[152:155], v[44:47], v[8:11], v[152:155]
    ds_read_b128 v[72:75], v101 offset:36352
    v_cvt_pk_bf16_f32 v18, v144, v145
    s_waitcnt lgkmcnt(8)
    v_mfma_f32_16x16x32_bf16 v[168:171], v[48:51], v[8:11], v[168:171]
    ds_read_b128 v[76:79], v100 offset:36864
    v_cvt_pk_bf16_f32 v19, v146, v147
    v_mfma_f32_16x16x32_bf16 v[172:175], v[48:51], v[12:15], v[172:175]
    ds_read_b128 v[80:83], v101 offset:37376
    ds_write_b128 v104, v[16:19] offset:0
    v_cvt_pk_bf16_f32 v20, v160, v161
    s_waitcnt lgkmcnt(10)
    v_mfma_f32_16x16x32_bf16 v[188:191], v[52:55], v[12:15], v[188:191]
    ds_read_b128 v[84:87], v100 offset:37888
    v_cvt_pk_bf16_f32 v21, v162, v163
    v_mfma_f32_16x16x32_bf16 v[184:187], v[52:55], v[8:11], v[184:187]
    ds_read_b128 v[88:91], v101 offset:38400
    v_cvt_pk_bf16_f32 v22, v176, v177
    s_waitcnt lgkmcnt(11)
    v_mfma_f32_16x16x32_bf16 v[200:203], v[56:59], v[8:11], v[200:203]
    ds_read_b128 v[92:95], v100 offset:38912
    v_cvt_pk_bf16_f32 v23, v178, v179
    ds_write_b128 v104, v[20:23] offset:64
    v_mfma_f32_16x16x32_bf16 v[204:207], v[56:59], v[12:15], v[204:207]
    v_cvt_pk_bf16_f32 v32, v192, v193
    s_waitcnt lgkmcnt(12)
    v_mfma_f32_16x16x32_bf16 v[220:223], v[60:63], v[12:15], v[220:223]
    v_cvt_pk_bf16_f32 v33, v194, v195
    v_mfma_f32_16x16x32_bf16 v[216:219], v[60:63], v[8:11], v[216:219]
    v_cvt_pk_bf16_f32 v34, v208, v209
    s_waitcnt lgkmcnt(11)
    v_mfma_f32_16x16x32_bf16 v[232:235], v[64:67], v[8:11], v[232:235]
    v_cvt_pk_bf16_f32 v35, v210, v211
    ds_write_b128 v104, v[32:35] offset:128
    v_mfma_f32_16x16x32_bf16 v[236:239], v[64:67], v[12:15], v[236:239]
    v_cvt_pk_bf16_f32 v36, v224, v225
    s_waitcnt lgkmcnt(9)
    v_mfma_f32_16x16x32_bf16 v[136:139], v[68:71], v[24:27], v[136:139]
    ds_read_b128 v[8:11], v96 offset:4096
    v_cvt_pk_bf16_f32 v37, v226, v227
    v_mfma_f32_16x16x32_bf16 v[140:143], v[68:71], v[28:31], v[140:143]
    ds_read_b128 v[12:15], v96 offset:6144
    ds_write_b64 v105, v[36:37] offset:192
    ds_read_b128 v[112:115], v106 offset:0
    s_waitcnt lgkmcnt(12)
    v_mfma_f32_16x16x32_bf16 v[156:159], v[72:75], v[28:31], v[156:159]
    ds_read_b128 v[40:43], v100 offset:0
    ds_read_b128 v[116:119], v106 offset:960
    v_mfma_f32_16x16x32_bf16 v[152:155], v[72:75], v[24:27], v[152:155]
    ds_read_b128 v[44:47], v101 offset:512
    ds_read_b128 v[120:123], v106 offset:1920
    s_waitcnt lgkmcnt(15)
    v_mfma_f32_16x16x32_bf16 v[168:171], v[76:79], v[24:27], v[168:171]
    ds_read_b128 v[48:51], v100 offset:1024
    ds_read_b128 v[124:127], v106 offset:2880
    s_mov_b32 s44, 0
    s_waitcnt lgkmcnt(6)
    buffer_store_dwordx4 v[112:115], v107, s[32:35], s44 offen nt
    v_mfma_f32_16x16x32_bf16 v[172:175], v[76:79], v[28:31], v[172:175]
    ds_read_b128 v[52:55], v101 offset:1536
    s_mov_b32 s44, 28672
    s_waitcnt lgkmcnt(5)
    buffer_store_dwordx4 v[116:119], v107, s[32:35], s44 offen nt
    v_mfma_f32_16x16x32_bf16 v[188:191], v[80:83], v[28:31], v[188:191]
    ds_read_b128 v[56:59], v100 offset:2048
    s_mov_b32 s44, 57344
    s_waitcnt lgkmcnt(4)
    buffer_store_dwordx4 v[120:123], v107, s[32:35], s44 offen nt
    v_mfma_f32_16x16x32_bf16 v[184:187], v[80:83], v[24:27], v[184:187]
    ds_read_b128 v[60:63], v101 offset:2560
    s_mov_b32 s44, 86016
    s_waitcnt lgkmcnt(3)
    buffer_store_dwordx4 v[124:127], v107, s[32:35], s44 offen nt
    v_mfma_f32_16x16x32_bf16 v[200:203], v[84:87], v[24:27], v[200:203]
    ds_read_b128 v[64:67], v100 offset:3072
    v_cvt_pk_bf16_f32 v16, v132, v133
    v_cvt_pk_bf16_f32 v17, v134, v135
    v_mfma_f32_16x16x32_bf16 v[204:207], v[84:87], v[28:31], v[204:207]
    v_cvt_pk_bf16_f32 v18, v148, v149
    v_mfma_f32_16x16x32_bf16 v[220:223], v[88:91], v[28:31], v[220:223]
    v_cvt_pk_bf16_f32 v19, v150, v151
    v_mfma_f32_16x16x32_bf16 v[216:219], v[88:91], v[24:27], v[216:219]
    ds_write_b128 v104, v[16:19] offset:3840
    v_cvt_pk_bf16_f32 v20, v164, v165
    v_mfma_f32_16x16x32_bf16 v[232:235], v[92:95], v[24:27], v[232:235]
    v_cvt_pk_bf16_f32 v21, v166, v167
    v_mfma_f32_16x16x32_bf16 v[236:239], v[92:95], v[28:31], v[236:239]
    v_cvt_pk_bf16_f32 v22, v180, v181
    v_mfma_f32_16x16x32_bf16 v[136:139], v[40:43], v[8:11], v[136:139]
    ds_read_b128 v[24:27], v97 offset:4096
    ds_read_b128 v[28:31], v97 offset:6144
    v_cvt_pk_bf16_f32 v23, v182, v183
    ds_write_b128 v104, v[20:23] offset:3904
    v_mfma_f32_16x16x32_bf16 v[152:155], v[44:47], v[8:11], v[152:155]
    ds_read_b128 v[68:71], v100 offset:7168
    ds_read_b128 v[72:75], v101 offset:7680
    v_cvt_pk_bf16_f32 v32, v196, v197
    v_mfma_f32_16x16x32_bf16 v[168:171], v[48:51], v[8:11], v[168:171]
    ds_read_b128 v[76:79], v100 offset:8192
    ds_read_b128 v[80:83], v101 offset:8704
    v_cvt_pk_bf16_f32 v33, v198, v199
    s_waitcnt lgkmcnt(11)
    v_mfma_f32_16x16x32_bf16 v[184:187], v[52:55], v[8:11], v[184:187]
    ds_read_b128 v[84:87], v100 offset:9216
    ds_read_b128 v[88:91], v101 offset:9728
    v_cvt_pk_bf16_f32 v34, v212, v213
    s_waitcnt lgkmcnt(12)
    v_mfma_f32_16x16x32_bf16 v[200:203], v[56:59], v[8:11], v[200:203]
    ds_read_b128 v[92:95], v100 offset:10240
    v_cvt_pk_bf16_f32 v35, v214, v215
    ds_write_b128 v104, v[32:35] offset:3968
    s_waitcnt lgkmcnt(13)
    v_mfma_f32_16x16x32_bf16 v[216:219], v[60:63], v[8:11], v[216:219]
    v_cvt_pk_bf16_f32 v36, v228, v229
    s_waitcnt lgkmcnt(12)
    v_mfma_f32_16x16x32_bf16 v[232:235], v[64:67], v[8:11], v[232:235]
    v_cvt_pk_bf16_f32 v37, v230, v231
    s_waitcnt lgkmcnt(7)
    v_mfma_f32_16x16x32_bf16 v[136:139], v[68:71], v[24:27], v[136:139]
    ds_write_b64 v105, v[36:37] offset:4032
    ds_read_b128 v[240:243], v106 offset:3840
    s_waitcnt lgkmcnt(8)
    v_mfma_f32_16x16x32_bf16 v[152:155], v[72:75], v[24:27], v[152:155]
    ds_read_b128 v[244:247], v106 offset:4800
    s_waitcnt lgkmcnt(8)
    v_mfma_f32_16x16x32_bf16 v[168:171], v[76:79], v[24:27], v[168:171]
    ds_read_b128 v[248:251], v106 offset:5760
    s_waitcnt lgkmcnt(8)
    v_mfma_f32_16x16x32_bf16 v[184:187], v[80:83], v[24:27], v[184:187]
    ds_read_b128 v[252:255], v106 offset:6720
    s_mov_b32 s44, 114688
    s_waitcnt lgkmcnt(3)
    buffer_store_dwordx4 v[240:243], v107, s[32:35], s44 offen nt
    v_mfma_f32_16x16x32_bf16 v[200:203], v[84:87], v[24:27], v[200:203]
    s_mov_b32 s44, 143360
    s_waitcnt lgkmcnt(2)
    buffer_store_dwordx4 v[244:247], v107, s[32:35], s44 offen nt
    v_mfma_f32_16x16x32_bf16 v[216:219], v[88:91], v[24:27], v[216:219]
    s_mov_b32 s44, 172032
    s_waitcnt lgkmcnt(1)
    buffer_store_dwordx4 v[248:251], v107, s[32:35], s44 offen nt
    v_mfma_f32_16x16x32_bf16 v[232:235], v[92:95], v[24:27], v[232:235]
    s_mov_b32 s44, 200704
    s_waitcnt lgkmcnt(0)
    buffer_store_dwordx4 v[252:255], v107, s[32:35], s44 offen nt
    v_mfma_f32_16x16x32_bf16 v[140:143], v[40:43], v[12:15], v[140:143]
    v_mfma_f32_16x16x32_bf16 v[156:159], v[44:47], v[12:15], v[156:159]
    v_mfma_f32_16x16x32_bf16 v[172:175], v[48:51], v[12:15], v[172:175]
    v_cvt_pk_bf16_f32 v16, v136, v137
    v_cvt_pk_bf16_f32 v17, v138, v139
    v_cvt_pk_bf16_f32 v18, v152, v153
    v_mfma_f32_16x16x32_bf16 v[188:191], v[52:55], v[12:15], v[188:191]
    v_cvt_pk_bf16_f32 v19, v154, v155
    ds_write_b128 v104, v[16:19] offset:0
    v_mfma_f32_16x16x32_bf16 v[204:207], v[56:59], v[12:15], v[204:207]
    v_cvt_pk_bf16_f32 v20, v168, v169
    v_cvt_pk_bf16_f32 v21, v170, v171
    v_mfma_f32_16x16x32_bf16 v[220:223], v[60:63], v[12:15], v[220:223]
    v_cvt_pk_bf16_f32 v22, v184, v185
    v_cvt_pk_bf16_f32 v23, v186, v187
    v_mfma_f32_16x16x32_bf16 v[236:239], v[64:67], v[12:15], v[236:239]
    ds_write_b128 v104, v[20:23] offset:64
    v_cvt_pk_bf16_f32 v32, v200, v201
    v_mfma_f32_16x16x32_bf16 v[140:143], v[68:71], v[28:31], v[140:143]
    v_cvt_pk_bf16_f32 v33, v202, v203
    v_cvt_pk_bf16_f32 v34, v216, v217
    v_mfma_f32_16x16x32_bf16 v[156:159], v[72:75], v[28:31], v[156:159]
    v_cvt_pk_bf16_f32 v35, v218, v219
    ds_write_b128 v104, v[32:35] offset:128
    v_cvt_pk_bf16_f32 v36, v232, v233
    v_mfma_f32_16x16x32_bf16 v[172:175], v[76:79], v[28:31], v[172:175]
    v_cvt_pk_bf16_f32 v37, v234, v235
    ds_write_b64 v105, v[36:37] offset:192
    v_mfma_f32_16x16x32_bf16 v[188:191], v[80:83], v[28:31], v[188:191]
    ds_read_b128 v[112:115], v106 offset:0
    ds_read_b128 v[116:119], v106 offset:960
    v_mfma_f32_16x16x32_bf16 v[204:207], v[84:87], v[28:31], v[204:207]
    ds_read_b128 v[120:123], v106 offset:1920
    ds_read_b128 v[124:127], v106 offset:2880
    v_mfma_f32_16x16x32_bf16 v[220:223], v[88:91], v[28:31], v[220:223]
    s_mov_b32 s44, 229376
    s_waitcnt lgkmcnt(3)
    buffer_store_dwordx4 v[112:115], v107, s[32:35], s44 offen
    s_mov_b32 s44, 258048
    s_waitcnt lgkmcnt(2)
    buffer_store_dwordx4 v[116:119], v107, s[32:35], s44 offen
    v_mfma_f32_16x16x32_bf16 v[236:239], v[92:95], v[28:31], v[236:239]
    s_mov_b32 s44, 286720
    s_waitcnt lgkmcnt(1)
    buffer_store_dwordx4 v[120:123], v107, s[32:35], s44 offen
    s_mov_b32 s44, 315392
    s_waitcnt lgkmcnt(0)
    buffer_store_dwordx4 v[124:127], v107, s[32:35], s44 offen
    s_nop 7
    s_nop 1
    v_cvt_pk_bf16_f32 v16, v140, v141
    v_cvt_pk_bf16_f32 v17, v142, v143
    v_cvt_pk_bf16_f32 v18, v156, v157
    v_cvt_pk_bf16_f32 v19, v158, v159
    ds_write_b128 v104, v[16:19] offset:3840
    v_cvt_pk_bf16_f32 v20, v172, v173
    v_cvt_pk_bf16_f32 v21, v174, v175
    v_cvt_pk_bf16_f32 v22, v188, v189
    v_cvt_pk_bf16_f32 v23, v190, v191
    ds_write_b128 v104, v[20:23] offset:3904
    v_cvt_pk_bf16_f32 v32, v204, v205
    v_cvt_pk_bf16_f32 v33, v206, v207
    v_cvt_pk_bf16_f32 v34, v220, v221
    v_cvt_pk_bf16_f32 v35, v222, v223
    ds_write_b128 v104, v[32:35] offset:3968
    v_cvt_pk_bf16_f32 v36, v236, v237
    v_cvt_pk_bf16_f32 v37, v238, v239
    ds_write_b64 v105, v[36:37] offset:4032
    ds_read_b128 v[240:243], v106 offset:3840
    ds_read_b128 v[244:247], v106 offset:4800
    ds_read_b128 v[248:251], v106 offset:5760
    ds_read_b128 v[252:255], v106 offset:6720
    s_mov_b32 s44, 344064
    s_waitcnt lgkmcnt(3)
    buffer_store_dwordx4 v[240:243], v107, s[32:35], s44 offen
    s_mov_b32 s44, 372736
    s_waitcnt lgkmcnt(2)
    buffer_store_dwordx4 v[244:247], v107, s[32:35], s44 offen
    s_mov_b32 s44, 401408
    s_waitcnt lgkmcnt(1)
    buffer_store_dwordx4 v[248:251], v107, s[32:35], s44 offen
    s_mov_b32 s44, 430080
    s_waitcnt lgkmcnt(0)
    buffer_store_dwordx4 v[252:255], v107, s[32:35], s44 offen
    s_endpgm
L_help:
    s_sub_u32 s39, s39, 4
    s_mov_b32 s16, s4
    s_mov_b32 s17, s5
    s_mov_b32 s18, 4194304
    s_mov_b32 s19, 0x20000
    s_mov_b32 s4, s14
    s_mov_b32 s5, s15
    s_mov_b32 s6, 7475200
    s_mov_b32 s7, 0x20000
    v_lshrrev_b32 v7, 3, v0
    v_lshlrev_b32 v7, 11, v7
    v_and_b32 v6, 7, v0
    v_lshl_add_u32 v81, v6, 7, v7
    v_add_u32 v82, 1024, v81
    s_lshl_b32 s40, s37, 8
    s_lshl_b32 s41, s36, 3
    s_add_u32 s40, s40, s41
    s_lshl_b32 s58, s40, 11
    v_lshrrev_b32 v3, 3, v0
    s_lshl_b32 s42, s37, 8
    s_lshl_b32 s43, s51, 6
    s_add_u32 s42, s42, s43
    v_add_u32 v3, s42, v3
    v_lshlrev_b32 v3, 11, v3
    v_and_b32 v5, 7, v0
    v_lshrrev_b32 v6, 4, v0
    v_xor_b32 v5, v5, v6
    v_lshl_add_u32 v72, v5, 4, v3
    v_xor_b32 v5, 64, v72
    s_lshl_b32 s47, s51, 13
    v_add_u32 v73, 15360, v5
    v_add_u32 v74, 30720, v72
    v_add_u32 v75, 46080, v5
    v_add_u32 v76, 65536, v72
    v_add_u32 v77, 80896, v5
    v_add_u32 v78, 96256, v72
    v_add_u32 v79, 111616, v5
    s_lshl_b32 s44, s36, 7
    s_add_u32 s44, s44, 7471104
    v_and_b32 v5, 7, v0
    v_lshlrev_b32 v5, 2, v5
    buffer_load_dword v84, v5, s[4:7], s44 offen sc1
    buffer_load_dwordx2 v[24:25], v4, s[24:27], s49 offen
    buffer_load_dwordx2 v[26:27], v4, s[28:31], s49 offen
    buffer_load_dwordx4 v[128:131], v16, s[20:23], s48 offen
    s_lshl_b32 s53, s37, 1
    s_lshl_b32 s46, s53, 7
    s_add_u32 m0, s47, 0
    s_nop 0
    buffer_load_dwordx4 v72, s[16:19], s46 offen offset:0  lds
    buffer_load_dwordx4 v[132:135], v17, s[20:23], s48 offen
    buffer_load_dwordx4 v73, s[16:19], s46 offen offset:1024  lds
    buffer_load_dwordx4 v[136:139], v18, s[20:23], s48 offen
    buffer_load_dwordx4 v74, s[16:19], s46 offen offset:2048  lds
    buffer_load_dwordx4 v[140:143], v19, s[20:23], s48 offen
    buffer_load_dwordx4 v[144:147], v20, s[20:23], s48 offen
    s_barrier
    buffer_load_dwordx4 v75, s[16:19], s46 offen offset:3072  lds
    s_add_u32 m0, s47, 4096
    s_nop 0
    buffer_load_dwordx4 v76, s[16:19], s46 offen offset:0  lds
    buffer_load_dwordx4 v77, s[16:19], s46 offen offset:1024  lds
    buffer_load_dwordx4 v78, s[16:19], s46 offen offset:2048  lds
    buffer_load_dwordx4 v79, s[16:19], s46 offen offset:3072  lds
    buffer_load_dwordx4 v[148:151], v21, s[20:23], s48 offen
    buffer_load_dwordx4 v[152:155], v22, s[20:23], s48 offen
    buffer_load_dwordx4 v[156:159], v23, s[20:23], s48 offen
    s_cmp_lg_u32 s39, 0
    s_cbranch_scc1 L_1
    buffer_load_dword v83, v81, s[16:19], s58 offen
L_1:
    s_cmp_lg_u32 s39, 1
    s_cbranch_scc1 L_2
    buffer_load_dword v83, v82, s[16:19], s58 offen
L_2:
    s_lshl_b32 s44, s36, 7
    s_add_u32 s44, s44, 7471104
    v_and_b32 v5, 7, v0
    v_lshlrev_b32 v86, 7, v5
    s_lshl_b32 s45, s37, 2
    s_add_u32 s44, s44, s45
    s_lshl_b32 s45, s36, 12
    s_add_u32 s45, s45, 7340032
    v_add_u32 v86, s45, v86
    v_lshrrev_b32 v3, 3, v1
    v_lshlrev_b32 v3, 3, v3
    v_and_b32 v5, 1, v1
    v_lshl_add_u32 v3, v5, 2, v3
    v_bfe_u32 v5, v1, 1, 2
    v_add_u32 v3, v3, v5
    v_cmp_le_u32 vcc, 24, v1
    s_mul_i32 s42, s51, 3584
    s_add_u32 s40, s42, 112640
    v_cndmask_b32 v3, v3, v1, vcc
    v_and_b32 v5, 7, v3
    v_xor_b32 v5, v5, v2
    v_lshlrev_b32 v3, 7, v3
    v_add_u32 v3, s40, v3
    v_xor_b32 v6, 0, v5
    v_lshl_add_u32 v40, v6, 4, v3
    v_xor_b32 v6, 2, v5
    v_lshl_add_u32 v41, v6, 4, v3
    v_xor_b32 v6, 4, v5
    v_lshl_add_u32 v42, v6, 4, v3
    v_xor_b32 v6, 6, v5
    v_lshl_add_u32 v43, v6, 4, v3
    v_lshlrev_b32 v5, 4, v0
    v_add_u32 v68, s40, v5
    s_lshl_b32 s41, s36, 4
    s_add_u32 s41, s41, s50
    s_mul_i32 s41, s41, 14336
    s_add_u32 s41, s41, s42
    v_add_u32 v69, s41, v5
    s_lshl_b32 s55, s39, 12
    s_cmp_eq_u32 s39, 3
    s_cselect_b32 s44, 1024, 0
    s_sub_u32 s55, s55, s44
    v_lshlrev_b32 v5, 4, v0
    v_add_u32 v80, s55, v5
    s_mul_i32 s57, s36, 229376
    s_mov_b32 s89, 0
    s_waitcnt vmcnt(16)
    v_lshlrev_b32 v28, 16, v24
    v_and_b32 v29, 0xffff0000, v24
    v_lshlrev_b32 v30, 16, v25
    v_and_b32 v31, 0xffff0000, v25
    v_lshlrev_b32 v36, 16, v26
    v_and_b32 v37, 0xffff0000, v26
    v_lshlrev_b32 v38, 16, v27
    v_and_b32 v39, 0xffff0000, v27
    v_mul_f32_e64 v32, -v36, v28
    v_mul_f32_e64 v33, -v37, v29
    v_mul_f32_e64 v34, -v38, v30
    v_mul_f32_e64 v35, -v39, v31
    s_waitcnt vmcnt(13)
    v_cvt_f32_i32 v60, v128
    v_cvt_f32_i32 v61, v132
    v_cvt_f32_i32 v62, v129
    v_cvt_f32_i32 v63, v133
    v_cvt_f32_i32 v64, v130
    v_cvt_f32_i32 v65, v134
    v_cvt_f32_i32 v66, v131
    v_cvt_f32_i32 v67, v135
    v_fma_f32 v60, v60, v28, v32
    v_fma_f32 v61, v61, v28, v32
    v_fma_f32 v62, v62, v29, v33
    v_fma_f32 v63, v63, v29, v33
    v_fma_f32 v64, v64, v30, v34
    v_fma_f32 v65, v65, v30, v34
    v_fma_f32 v66, v66, v31, v35
    v_fma_f32 v67, v67, v31, v35
    v_cvt_pk_bf16_f32 v44, v60, v61
    v_cvt_pk_bf16_f32 v48, v62, v63
    v_cvt_pk_bf16_f32 v52, v64, v65
    v_cvt_pk_bf16_f32 v56, v66, v67
    s_waitcnt vmcnt(9)
    v_cvt_f32_i32 v60, v136
    v_cvt_f32_i32 v61, v140
    v_cvt_f32_i32 v62, v137
    v_cvt_f32_i32 v63, v141
    v_cvt_f32_i32 v64, v138
    v_cvt_f32_i32 v65, v142
    v_cvt_f32_i32 v66, v139
    v_cvt_f32_i32 v67, v143
    v_fma_f32 v60, v60, v28, v32
    v_fma_f32 v61, v61, v28, v32
    v_fma_f32 v62, v62, v29, v33
    v_fma_f32 v63, v63, v29, v33
    v_fma_f32 v64, v64, v30, v34
    v_fma_f32 v65, v65, v30, v34
    v_fma_f32 v66, v66, v31, v35
    v_fma_f32 v67, v67, v31, v35
    v_cvt_pk_bf16_f32 v45, v60, v61
    v_cvt_pk_bf16_f32 v49, v62, v63
    v_cvt_pk_bf16_f32 v53, v64, v65
    v_cvt_pk_bf16_f32 v57, v66, v67
    s_waitcnt vmcnt(3)
    s_barrier
    s_lshl_b32 s53, s37, 1
    s_add_u32 s53, s53, 1
    s_lshl_b32 s46, s53, 7
    s_add_u32 m0, s47, 32768
    s_nop 0
    buffer_load_dwordx4 v72, s[16:19], s46 offen offset:0  lds
    s_waitcnt vmcnt(3)
    v_cvt_f32_i32 v60, v144
    v_cvt_f32_i32 v61, v148
    v_cvt_f32_i32 v62, v145
    buffer_load_dwordx4 v73, s[16:19], s46 offen offset:1024  lds
    v_cvt_f32_i32 v63, v149
    v_cvt_f32_i32 v64, v146
    v_cvt_f32_i32 v65, v150
    buffer_load_dwordx4 v74, s[16:19], s46 offen offset:2048  lds
    v_cvt_f32_i32 v66, v147
    v_cvt_f32_i32 v67, v151
    v_fma_f32 v60, v60, v28, v32
    buffer_load_dwordx4 v75, s[16:19], s46 offen offset:3072  lds
    v_fma_f32 v61, v61, v28, v32
    v_fma_f32 v62, v62, v29, v33
    v_fma_f32 v63, v63, v29, v33
    s_add_u32 m0, s47, 36864
    s_nop 0
    buffer_load_dwordx4 v76, s[16:19], s46 offen offset:0  lds
    v_fma_f32 v64, v64, v30, v34
    v_fma_f32 v65, v65, v30, v34
    v_fma_f32 v66, v66, v31, v35
    buffer_load_dwordx4 v77, s[16:19], s46 offen offset:1024  lds
    v_fma_f32 v67, v67, v31, v35
    v_cvt_pk_bf16_f32 v46, v60, v61
    v_cvt_pk_bf16_f32 v50, v62, v63
    buffer_load_dwordx4 v78, s[16:19], s46 offen offset:2048  lds
    v_cvt_pk_bf16_f32 v54, v64, v65
    v_cvt_pk_bf16_f32 v58, v66, v67
    s_waitcnt vmcnt(7)
    buffer_load_dwordx4 v79, s[16:19], s46 offen offset:3072  lds
    v_cvt_f32_i32 v60, v152
    v_cvt_f32_i32 v61, v156
    s_mov_b64 exec, 0xff
    buffer_load_dwordx2 v[88:89], v86, s[4:7], 0 offen offset:0 sc1
    s_mov_b64 exec, -1
    v_cvt_f32_i32 v62, v153
    v_cvt_f32_i32 v63, v157
    v_cvt_f32_i32 v64, v154
    v_cvt_f32_i32 v65, v158
    v_cvt_f32_i32 v66, v155
    v_cvt_f32_i32 v67, v159
    v_fma_f32 v60, v60, v28, v32
    v_fma_f32 v61, v61, v28, v32
    v_fma_f32 v62, v62, v29, v33
    v_fma_f32 v63, v63, v29, v33
    v_fma_f32 v64, v64, v30, v34
    v_fma_f32 v65, v65, v30, v34
    v_fma_f32 v66, v66, v31, v35
    v_fma_f32 v67, v67, v31, v35
    v_cvt_pk_bf16_f32 v47, v60, v61
    ds_write_b128 v40, v[44:47]
    v_cvt_pk_bf16_f32 v51, v62, v63
    ds_write_b128 v41, v[48:51]
    v_cvt_pk_bf16_f32 v55, v64, v65
    ds_write_b128 v42, v[52:55]
    v_cvt_pk_bf16_f32 v59, v66, v67
    ds_write_b128 v43, v[56:59]
    v_readlane_b32 s52, v84, s37
    v_xor_b32 v5, 59797, v84
    v_and_b32 v5, 0xffff, v5
    v_mul_u32_u24 v85, 0x10001, v5
    s_waitcnt lgkmcnt(0)
    s_waitcnt vmcnt(0)
    v_cmp_eq_u32 vcc, v88, v85
    v_cmp_eq_u32 s[44:45], v89, v85
    s_nop 1
    s_and_b32 s89, s44, vcc_lo
    s_add_u32 s53, s37, 1
    s_and_b32 s53, s53, 3
    s_and_b32 s44, s37, 4
    s_or_b32 s53, s53, s44
    s_lshl_b32 s53, s53, 1
    s_add_u32 s56, s55, 126976
    s_lshr_b32 s99, s53, 1
    s_bitcmp1_b32 s89, s99
    s_cbranch_scc1 L_3
    s_movk_i32 s91, 0
    s_mov_b32 s92, 126976
    s_getpc_b64 s[94:95]
L_4:
    s_add_u32 s94, s94, L_slow-L_4
    s_addc_u32 s95, s95, 0
    s_swappc_b64 s[96:97], s[94:95]
L_3:
    s_mul_i32 s54, s53, 14336
    s_mov_b32 m0, s56
    s_add_u32 s54, s54, s57
    buffer_load_dwordx4 v80, s[4:7], s54 offen offset:0 sc1 lds
    buffer_load_dwordx4 v80, s[4:7], s54 offen offset:1024 sc1 lds
    buffer_load_dwordx4 v80, s[4:7], s54 offen offset:2048 sc1 lds
    s_cmp_ge_u32 s39, 2
    s_cbranch_scc1 L_5
    buffer_load_dwordx4 v80, s[4:7], s54 offen offset:3072 sc1 lds
L_5:
    s_mov_b64 exec, 0xff
    buffer_load_dwordx2 v[88:89], v86, s[4:7], 0 offen offset:0 sc1
    s_mov_b64 exec, -1
    s_add_u32 s53, s37, 1
    s_and_b32 s53, s53, 3
    s_and_b32 s44, s37, 4
    s_or_b32 s53, s53, s44
    s_lshl_b32 s53, s53, 1
    s_lshl_b32 s46, s53, 7
    s_add_u32 m0, s47, 65536
    s_nop 0
    buffer_load_dwordx4 v72, s[16:19], s46 offen offset:0  lds
    buffer_load_dwordx4 v73, s[16:19], s46 offen offset:1024  lds
    buffer_load_dwordx4 v74, s[16:19], s46 offen offset:2048  lds
    buffer_load_dwordx4 v75, s[16:19], s46 offen offset:3072  lds
    s_add_u32 m0, s47, 69632
    s_nop 0
    buffer_load_dwordx4 v76, s[16:19], s46 offen offset:0  lds
    buffer_load_dwordx4 v77, s[16:19], s46 offen offset:1024  lds
    buffer_load_dwordx4 v78, s[16:19], s46 offen offset:2048  lds
    buffer_load_dwordx4 v79, s[16:19], s46 offen offset:3072  lds
    s_waitcnt lgkmcnt(0)
    s_barrier
    s_add_u32 s53, s37, 0
    s_and_b32 s53, s53, 3
    s_andn2_b32 s44, 4, s37
    s_or_b32 s53, s53, s44
    s_lshl_b32 s53, s53, 1
    s_lshl_b32 s46, s53, 7
    s_add_u32 m0, s47, 0
    s_nop 0
    buffer_load_dwordx4 v72, s[16:19], s46 offen offset:0  lds
    buffer_load_dwordx4 v73, s[16:19], s46 offen offset:1024  lds
    buffer_load_dwordx4 v74, s[16:19], s46 offen offset:2048  lds
    buffer_load_dwordx4 v75, s[16:19], s46 offen offset:3072  lds
    s_add_u32 m0, s47, 4096
    s_nop 0
    buffer_load_dwordx4 v76, s[16:19], s46 offen offset:0  lds
    buffer_load_dwordx4 v77, s[16:19], s46 offen offset:1024  lds
    buffer_load_dwordx4 v78, s[16:19], s46 offen offset:2048  lds
    buffer_load_dwordx4 v79, s[16:19], s46 offen offset:3072  lds
    s_waitcnt vmcnt(16)
    v_cmp_eq_u32 vcc, v88, v85
    v_cmp_eq_u32 s[44:45], v89, v85
    s_nop 1
    s_and_b32 s89, s44, vcc_lo
    s_add_u32 s53, s37, 0
    s_and_b32 s53, s53, 3
    s_andn2_b32 s44, 4, s37
    s_or_b32 s53, s53, s44
    s_lshl_b32 s53, s53, 1
    s_add_u32 s56, s55, 98304
    s_lshr_b32 s99, s53, 1
    s_bitcmp1_b32 s89, s99
    s_cbranch_scc1 L_6
    s_movk_i32 s91, 0
    s_mov_b32 s92, 98304
    s_getpc_b64 s[94:95]
L_7:
    s_add_u32 s94, s94, L_slow-L_7
    s_addc_u32 s95, s95, 0
    s_swappc_b64 s[96:97], s[94:95]
L_6:
    s_mul_i32 s54, s53, 14336
    s_mov_b32 m0, s56
    s_add_u32 s54, s54, s57
    buffer_load_dwordx4 v80, s[4:7], s54 offen offset:0 sc1 lds
    buffer_load_dwordx4 v80, s[4:7], s54 offen offset:1024 sc1 lds
    buffer_load_dwordx4 v80, s[4:7], s54 offen offset:2048 sc1 lds
    s_cmp_ge_u32 s39, 2
    s_cbranch_scc1 L_8
    buffer_load_dwordx4 v80, s[4:7], s54 offen offset:3072 sc1 lds
L_8:
    s_waitcnt vmcnt(11)
    s_barrier
    s_add_u32 s53, s37, 2
    s_and_b32 s53, s53, 3
    s_and_b32 s44, s37, 4
    s_or_b32 s53, s53, s44
    s_lshl_b32 s53, s53, 1
    s_lshl_b32 s46, s53, 7
    s_add_u32 m0, s47, 32768
    s_nop 0
    buffer_load_dwordx4 v72, s[16:19], s46 offen offset:0  lds
    buffer_load_dwordx4 v73, s[16:19], s46 offen offset:1024  lds
    buffer_load_dwordx4 v74, s[16:19], s46 offen offset:2048  lds
    buffer_load_dwordx4 v75, s[16:19], s46 offen offset:3072  lds
    s_add_u32 m0, s47, 36864
    s_nop 0
    buffer_load_dwordx4 v76, s[16:19], s46 offen offset:0  lds
    buffer_load_dwordx4 v77, s[16:19], s46 offen offset:1024  lds
    buffer_load_dwordx4 v78, s[16:19], s46 offen offset:2048  lds
    buffer_load_dwordx4 v79, s[16:19], s46 offen offset:3072  lds
    s_add_u32 s53, s37, 2
    s_and_b32 s53, s53, 3
    s_and_b32 s44, s37, 4
    s_or_b32 s53, s53, s44
    s_lshl_b32 s53, s53, 1
    s_add_u32 s56, s55, 112640
    s_lshr_b32 s99, s53, 1
    s_bitcmp1_b32 s89, s99
    s_cbranch_scc1 L_9
    s_movk_i32 s91, 0
    s_mov_b32 s92, 112640
    s_getpc_b64 s[94:95]
L_10:
    s_add_u32 s94, s94, L_slow-L_10
    s_addc_u32 s95, s95, 0
    s_swappc_b64 s[96:97], s[94:95]
L_9:
    s_mul_i32 s54, s53, 14336
    s_mov_b32 m0, s56
    s_add_u32 s54, s54, s57
    buffer_load_dwordx4 v80, s[4:7], s54 offen offset:0 sc1 lds
    buffer_load_dwordx4 v80, s[4:7], s54 offen offset:1024 sc1 lds
    buffer_load_dwordx4 v80, s[4:7], s54 offen offset:2048 sc1 lds
    s_cmp_ge_u32 s39, 2
    s_cbranch_scc1 L_11
    buffer_load_dwordx4 v80, s[4:7], s54 offen offset:3072 sc1 lds
L_11:
    s_waitcnt vmcnt(14)
    s_waitcnt vmcnt(11)
    s_barrier
    s_add_u32 s53, s37, 1
    s_and_b32 s53, s53, 3
    s_andn2_b32 s44, 4, s37
    s_or_b32 s53, s53, s44
    s_lshl_b32 s53, s53, 1
    s_lshl_b32 s46, s53, 7
    s_add_u32 m0, s47, 65536
    s_nop 0
    buffer_load_dwordx4 v72, s[16:19], s46 offen offset:0  lds
    buffer_load_dwordx4 v73, s[16:19], s46 offen offset:1024  lds
    buffer_load_dwordx4 v74, s[16:19], s46 offen offset:2048  lds
    buffer_load_dwordx4 v75, s[16:19], s46 offen offset:3072  lds
    s_add_u32 m0, s47, 69632
    s_nop 0
    buffer_load_dwordx4 v76, s[16:19], s46 offen offset:0  lds
    buffer_load_dwordx4 v77, s[16:19], s46 offen offset:1024  lds
    buffer_load_dwordx4 v78, s[16:19], s46 offen offset:2048  lds
    buffer_load_dwordx4 v79, s[16:19], s46 offen offset:3072  lds
    s_add_u32 s53, s37, 1
    s_and_b32 s53, s53, 3
    s_andn2_b32 s44, 4, s37
    s_or_b32 s53, s53, s44
    s_lshl_b32 s53, s53, 1
    s_add_u32 s56, s55, 126976
    s_lshr_b32 s99, s53, 1
    s_bitcmp1_b32 s89, s99
    s_cbranch_scc1 L_12
    s_movk_i32 s91, 0
    s_mov_b32 s92, 126976
    s_getpc_b64 s[94:95]
L_13:
    s_add_u32 s94, s94, L_slow-L_13
    s_addc_u32 s95, s95, 0
    s_swappc_b64 s[96:97], s[94:95]
L_12:
    s_mul_i32 s54, s53, 14336
    s_mov_b32 m0, s56
    s_add_u32 s54, s54, s57
    buffer_load_dwordx4 v80, s[4:7], s54 offen offset:0 sc1 lds
    buffer_load_dwordx4 v80, s[4:7], s54 offen offset:1024 sc1 lds
    buffer_load_dwordx4 v80, s[4:7], s54 offen offset:2048 sc1 lds
    s_cmp_ge_u32 s39, 2
    s_cbranch_scc1 L_14
    buffer_load_dwordx4 v80, s[4:7], s54 offen offset:3072 sc1 lds
L_14:
    s_waitcnt vmcnt(14)
    s_waitcnt vmcnt(11)
    s_barrier
    s_add_u32 s53, s37, 3
    s_and_b32 s53, s53, 3
    s_and_b32 s44, s37, 4
    s_or_b32 s53, s53, s44
    s_lshl_b32 s53, s53, 1
    s_lshl_b32 s46, s53, 7
    s_add_u32 m0, s47, 0
    s_nop 0
    buffer_load_dwordx4 v72, s[16:19], s46 offen offset:0  lds
    buffer_load_dwordx4 v73, s[16:19], s46 offen offset:1024  lds
    buffer_load_dwordx4 v74, s[16:19], s46 offen offset:2048  lds
    buffer_load_dwordx4 v75, s[16:19], s46 offen offset:3072  lds
    s_add_u32 m0, s47, 4096
    s_nop 0
    buffer_load_dwordx4 v76, s[16:19], s46 offen offset:0  lds
    buffer_load_dwordx4 v77, s[16:19], s46 offen offset:1024  lds
    buffer_load_dwordx4 v78, s[16:19], s46 offen offset:2048  lds
    buffer_load_dwordx4 v79, s[16:19], s46 offen offset:3072  lds
    s_add_u32 s53, s37, 3
    s_and_b32 s53, s53, 3
    s_and_b32 s44, s37, 4
    s_or_b32 s53, s53, s44
    s_lshl_b32 s53, s53, 1
    s_add_u32 s56, s55, 98304
    s_lshr_b32 s99, s53, 1
    s_bitcmp1_b32 s89, s99
    s_cbranch_scc1 L_15
    s_movk_i32 s91, 0
    s_mov_b32 s92, 98304
    s_getpc_b64 s[94:95]
L_16:
    s_add_u32 s94, s94, L_slow-L_16
    s_addc_u32 s95, s95, 0
    s_swappc_b64 s[96:97], s[94:95]
L_15:
    s_mul_i32 s54, s53, 14336
    s_mov_b32 m0, s56
    s_add_u32 s54, s54, s57
    buffer_load_dwordx4 v80, s[4:7], s54 offen offset:0 sc1 lds
    buffer_load_dwordx4 v80, s[4:7], s54 offen offset:1024 sc1 lds
    buffer_load_dwordx4 v80, s[4:7], s54 offen offset:2048 sc1 lds
    s_cmp_ge_u32 s39, 2
    s_cbranch_scc1 L_17
    buffer_load_dwordx4 v80, s[4:7], s54 offen offset:3072 sc1 lds
L_17:
    s_waitcnt vmcnt(14)
    s_waitcnt vmcnt(11)
    s_barrier
    s_add_u32 s53, s37, 2
    s_and_b32 s53, s53, 3
    s_andn2_b32 s44, 4, s37
    s_or_b32 s53, s53, s44
    s_lshl_b32 s53, s53, 1
    s_lshl_b32 s46, s53, 7
    s_add_u32 m0, s47, 32768
    s_nop 0
    buffer_load_dwordx4 v72, s[16:19], s46 offen offset:0  lds
    buffer_load_dwordx4 v73, s[16:19], s46 offen offset:1024  lds
    buffer_load_dwordx4 v74, s[16:19], s46 offen offset:2048  lds
    buffer_load_dwordx4 v75, s[16:19], s46 offen offset:3072  lds
    s_add_u32 m0, s47, 36864
    s_nop 0
    buffer_load_dwordx4 v76, s[16:19], s46 offen offset:0  lds
    buffer_load_dwordx4 v77, s[16:19], s46 offen offset:1024  lds
    buffer_load_dwordx4 v78, s[16:19], s46 offen offset:2048  lds
    buffer_load_dwordx4 v79, s[16:19], s46 offen offset:3072  lds
    s_add_u32 s53, s37, 2
    s_and_b32 s53, s53, 3
    s_andn2_b32 s44, 4, s37
    s_or_b32 s53, s53, s44
    s_lshl_b32 s53, s53, 1
    s_add_u32 s56, s55, 112640
    s_lshr_b32 s99, s53, 1
    s_bitcmp1_b32 s89, s99
    s_cbranch_scc1 L_18
    s_movk_i32 s91, 0
    s_mov_b32 s92, 112640
    s_getpc_b64 s[94:95]
L_19:
    s_add_u32 s94, s94, L_slow-L_19
    s_addc_u32 s95, s95, 0
    s_swappc_b64 s[96:97], s[94:95]
L_18:
    s_mul_i32 s54, s53, 14336
    s_mov_b32 m0, s56
    s_add_u32 s54, s54, s57
    buffer_load_dwordx4 v80, s[4:7], s54 offen offset:0 sc1 lds
    buffer_load_dwordx4 v80, s[4:7], s54 offen offset:1024 sc1 lds
    buffer_load_dwordx4 v80, s[4:7], s54 offen offset:2048 sc1 lds
    s_cmp_ge_u32 s39, 2
    s_cbranch_scc1 L_20
    buffer_load_dwordx4 v80, s[4:7], s54 offen offset:3072 sc1 lds
L_20:
    s_waitcnt vmcnt(14)
    s_waitcnt vmcnt(11)
    s_barrier
    s_add_u32 s53, s37, 3
    s_and_b32 s53, s53, 3
    s_andn2_b32 s44, 4, s37
    s_or_b32 s53, s53, s44
    s_lshl_b32 s53, s53, 1
    s_lshl_b32 s46, s53, 7
    s_add_u32 m0, s47, 65536
    s_nop 0
    buffer_load_dwordx4 v72, s[16:19], s46 offen offset:0  lds
    buffer_load_dwordx4 v73, s[16:19], s46 offen offset:1024  lds
    buffer_load_dwordx4 v74, s[16:19], s46 offen offset:2048  lds
    buffer_load_dwordx4 v75, s[16:19], s46 offen offset:3072  lds
    s_add_u32 m0, s47, 69632
    s_nop 0
    buffer_load_dwordx4 v76, s[16:19], s46 offen offset:0  lds
    buffer_load_dwordx4 v77, s[16:19], s46 offen offset:1024  lds
    buffer_load_dwordx4 v78, s[16:19], s46 offen offset:2048  lds
    buffer_load_dwordx4 v79, s[16:19], s46 offen offset:3072  lds
    s_add_u32 s53, s37, 3
    s_and_b32 s53, s53, 3
    s_andn2_b32 s44, 4, s37
    s_or_b32 s53, s53, s44
    s_lshl_b32 s53, s53, 1
    s_add_u32 s56, s55, 126976
    s_lshr_b32 s99, s53, 1
    s_bitcmp1_b32 s89, s99
    s_cbranch_scc1 L_21
    s_movk_i32 s91, 0
    s_mov_b32 s92, 126976
    s_getpc_b64 s[94:95]
L_22:
    s_add_u32 s94, s94, L_slow-L_22
    s_addc_u32 s95, s95, 0
    s_swappc_b64 s[96:97], s[94:95]
L_21:
    s_mul_i32 s54, s53, 14336
    s_mov_b32 m0, s56
    s_add_u32 s54, s54, s57
    buffer_load_dwordx4 v80, s[4:7], s54 offen offset:0 sc1 lds
    buffer_load_dwordx4 v80, s[4:7], s54 offen offset:1024 sc1 lds
    buffer_load_dwordx4 v80, s[4:7], s54 offen offset:2048 sc1 lds
    s_cmp_ge_u32 s39, 2
    s_cbranch_scc1 L_23
    buffer_load_dwordx4 v80, s[4:7], s54 offen offset:3072 sc1 lds
L_23:
    s_mov_b64 exec, 0xff
    buffer_load_dwordx2 v[88:89], v86, s[4:7], 0 offen offset:1024 sc1
    s_mov_b64 exec, -1
    s_waitcnt vmcnt(15)
    s_waitcnt vmcnt(12)
    s_barrier
    s_add_u32 s53, s37, 1
    s_and_b32 s53, s53, 3
    s_and_b32 s44, s37, 4
    s_or_b32 s53, s53, s44
    s_lshl_b32 s53, s53, 1
    s_add_u32 s53, s53, 1
    s_lshl_b32 s46, s53, 7
    s_add_u32 m0, s47, 0
    s_nop 0
    buffer_load_dwordx4 v72, s[16:19], s46 offen offset:0  lds
    buffer_load_dwordx4 v73, s[16:19], s46 offen offset:1024  lds
    buffer_load_dwordx4 v74, s[16:19], s46 offen offset:2048  lds
    buffer_load_dwordx4 v75, s[16:19], s46 offen offset:3072  lds
    s_add_u32 m0, s47, 4096
    s_nop 0
    buffer_load_dwordx4 v76, s[16:19], s46 offen offset:0  lds
    buffer_load_dwordx4 v77, s[16:19], s46 offen offset:1024  lds
    buffer_load_dwordx4 v78, s[16:19], s46 offen offset:2048  lds
    buffer_load_dwordx4 v79, s[16:19], s46 offen offset:3072  lds
    s_waitcnt vmcnt(8)
    v_cmp_eq_u32 vcc, v88, v85
    v_cmp_eq_u32 s[44:45], v89, v85
    s_nop 1
    s_and_b32 s90, s44, vcc_lo
    s_add_u32 s53, s37, 1
    s_and_b32 s53, s53, 3
    s_and_b32 s44, s37, 4
    s_or_b32 s53, s53, s44
    s_lshl_b32 s53, s53, 1
    s_add_u32 s53, s53, 1
    s_add_u32 s56, s55, 98304
    s_lshr_b32 s99, s53, 1
    s_bitcmp1_b32 s90, s99
    s_cbranch_scc1 L_24
    s_movk_i32 s91, 1024
    s_mov_b32 s92, 98304
    s_getpc_b64 s[94:95]
L_25:
    s_add_u32 s94, s94, L_slow-L_25
    s_addc_u32 s95, s95, 0
    s_swappc_b64 s[96:97], s[94:95]
L_24:
    s_mul_i32 s54, s53, 14336
    s_mov_b32 m0, s56
    s_add_u32 s54, s54, s57
    buffer_load_dwordx4 v80, s[4:7], s54 offen offset:0 sc1 lds
    buffer_load_dwordx4 v80, s[4:7], s54 offen offset:1024 sc1 lds
    buffer_load_dwordx4 v80, s[4:7], s54 offen offset:2048 sc1 lds
    s_cmp_ge_u32 s39, 2
    s_cbranch_scc1 L_26
    buffer_load_dwordx4 v80, s[4:7], s54 offen offset:3072 sc1 lds
L_26:
    s_barrier
    s_add_u32 s53, s37, 0
    s_and_b32 s53, s53, 3
    s_andn2_b32 s44, 4, s37
    s_or_b32 s53, s53, s44
    s_lshl_b32 s53, s53, 1
    s_add_u32 s53, s53, 1
    s_lshl_b32 s46, s53, 7
    s_add_u32 m0, s47, 32768
    s_nop 0
    buffer_load_dwordx4 v72, s[16:19], s46 offen offset:0  lds
    buffer_load_dwordx4 v73, s[16:19], s46 offen offset:1024  lds
    buffer_load_dwordx4 v74, s[16:19], s46 offen offset:2048  lds
    buffer_load_dwordx4 v75, s[16:19], s46 offen offset:3072  lds
    s_add_u32 m0, s47, 36864
    s_nop 0
    buffer_load_dwordx4 v76, s[16:19], s46 offen offset:0  lds
    buffer_load_dwordx4 v77, s[16:19], s46 offen offset:1024  lds
    buffer_load_dwordx4 v78, s[16:19], s46 offen offset:2048  lds
    buffer_load_dwordx4 v79, s[16:19], s46 offen offset:3072  lds
    s_add_u32 s53, s37, 0
    s_and_b32 s53, s53, 3
    s_andn2_b32 s44, 4, s37
    s_or_b32 s53, s53, s44
    s_lshl_b32 s53, s53, 1
    s_add_u32 s53, s53, 1
    s_add_u32 s56, s55, 112640
    s_lshr_b32 s99, s53, 1
    s_bitcmp1_b32 s90, s99
    s_cbranch_scc1 L_27
    s_movk_i32 s91, 1024
    s_mov_b32 s92, 112640
    s_getpc_b64 s[94:95]
L_28:
    s_add_u32 s94, s94, L_slow-L_28
    s_addc_u32 s95, s95, 0
    s_swappc_b64 s[96:97], s[94:95]
L_27:
    s_mul_i32 s54, s53, 14336
    s_mov_b32 m0, s56
    s_add_u32 s54, s54, s57
    buffer_load_dwordx4 v80, s[4:7], s54 offen offset:0 sc1 lds
    buffer_load_dwordx4 v80, s[4:7], s54 offen offset:1024 sc1 lds
    buffer_load_dwordx4 v80, s[4:7], s54 offen offset:2048 sc1 lds
    s_cmp_ge_u32 s39, 2
    s_cbranch_scc1 L_29
    buffer_load_dwordx4 v80, s[4:7], s54 offen offset:3072 sc1 lds
L_29:
    s_waitcnt vmcnt(14)
    s_waitcnt vmcnt(11)
    s_barrier
    s_add_u32 s53, s37, 2
    s_and_b32 s53, s53, 3
    s_and_b32 s44, s37, 4
    s_or_b32 s53, s53, s44
    s_lshl_b32 s53, s53, 1
    s_add_u32 s53, s53, 1
    s_lshl_b32 s46, s53, 7
    s_add_u32 m0, s47, 65536
    s_nop 0
    buffer_load_dwordx4 v72, s[16:19], s46 offen offset:0  lds
    buffer_load_dwordx4 v73, s[16:19], s46 offen offset:1024  lds
    buffer_load_dwordx4 v74, s[16:19], s46 offen offset:2048  lds
    buffer_load_dwordx4 v75, s[16:19], s46 offen offset:3072  lds
    s_add_u32 m0, s47, 69632
    s_nop 0
    buffer_load_dwordx4 v76, s[16:19], s46 offen offset:0  lds
    buffer_load_dwordx4 v77, s[16:19], s46 offen offset:1024  lds
    buffer_load_dwordx4 v78, s[16:19], s46 offen offset:2048  lds
    buffer_load_dwordx4 v79, s[16:19], s46 offen offset:3072  lds
    s_add_u32 s53, s37, 2
    s_and_b32 s53, s53, 3
    s_and_b32 s44, s37, 4
    s_or_b32 s53, s53, s44
    s_lshl_b32 s53, s53, 1
    s_add_u32 s53, s53, 1
    s_add_u32 s56, s55, 126976
    s_lshr_b32 s99, s53, 1
    s_bitcmp1_b32 s90, s99
    s_cbranch_scc1 L_30
    s_movk_i32 s91, 1024
    s_mov_b32 s92, 126976
    s_getpc_b64 s[94:95]
L_31:
    s_add_u32 s94, s94, L_slow-L_31
    s_addc_u32 s95, s95, 0
    s_swappc_b64 s[96:97], s[94:95]
L_30:
    s_mul_i32 s54, s53, 14336
    s_mov_b32 m0, s56
    s_add_u32 s54, s54, s57
    buffer_load_dwordx4 v80, s[4:7], s54 offen offset:0 sc1 lds
    buffer_load_dwordx4 v80, s[4:7], s54 offen offset:1024 sc1 lds
    buffer_load_dwordx4 v80, s[4:7], s54 offen offset:2048 sc1 lds
    s_cmp_ge_u32 s39, 2
    s_cbranch_scc1 L_32
    buffer_load_dwordx4 v80, s[4:7], s54 offen offset:3072 sc1 lds
L_32:
    s_waitcnt vmcnt(14)
    s_waitcnt vmcnt(11)
    s_barrier
    s_add_u32 s53, s37, 1
    s_and_b32 s53, s53, 3
    s_andn2_b32 s44, 4, s37
    s_or_b32 s53, s53, s44
    s_lshl_b32 s53, s53, 1
    s_add_u32 s53, s53, 1
    s_lshl_b32 s46, s53, 7
    s_add_u32 m0, s47, 0
    s_nop 0
    buffer_load_dwordx4 v72, s[16:19], s46 offen offset:0  lds
    buffer_load_dwordx4 v73, s[16:19], s46 offen offset:1024  lds
    buffer_load_dwordx4 v74, s[16:19], s46 offen offset:2048  lds
    buffer_load_dwordx4 v75, s[16:19], s46 offen offset:3072  lds
    s_add_u32 m0, s47, 4096
    s_nop 0
    buffer_load_dwordx4 v76, s[16:19], s46 offen offset:0  lds
    buffer_load_dwordx4 v77, s[16:19], s46 offen offset:1024  lds
    buffer_load_dwordx4 v78, s[16:19], s46 offen offset:2048  lds
    buffer_load_dwordx4 v79, s[16:19], s46 offen offset:3072  lds
    s_add_u32 s53, s37, 1
    s_and_b32 s53, s53, 3
    s_andn2_b32 s44, 4, s37
    s_or_b32 s53, s53, s44
    s_lshl_b32 s53, s53, 1
    s_add_u32 s53, s53, 1
    s_add_u32 s56, s55, 98304
    s_lshr_b32 s99, s53, 1
    s_bitcmp1_b32 s90, s99
    s_cbranch_scc1 L_33
    s_movk_i32 s91, 1024
    s_mov_b32 s92, 98304
    s_getpc_b64 s[94:95]
L_34:
    s_add_u32 s94, s94, L_slow-L_34
    s_addc_u32 s95, s95, 0
    s_swappc_b64 s[96:97], s[94:95]
L_33:
    s_mul_i32 s54, s53, 14336
    s_mov_b32 m0, s56
    s_add_u32 s54, s54, s57
    buffer_load_dwordx4 v80, s[4:7], s54 offen offset:0 sc1 lds
    buffer_load_dwordx4 v80, s[4:7], s54 offen offset:1024 sc1 lds
    buffer_load_dwordx4 v80, s[4:7], s54 offen offset:2048 sc1 lds
    s_cmp_ge_u32 s39, 2
    s_cbranch_scc1 L_35
    buffer_load_dwordx4 v80, s[4:7], s54 offen offset:3072 sc1 lds
L_35:
    s_waitcnt vmcnt(14)
    s_waitcnt vmcnt(11)
    s_barrier
    s_add_u32 s53, s37, 3
    s_and_b32 s53, s53, 3
    s_and_b32 s44, s37, 4
    s_or_b32 s53, s53, s44
    s_lshl_b32 s53, s53, 1
    s_add_u32 s53, s53, 1
    s_lshl_b32 s46, s53, 7
    s_add_u32 m0, s47, 32768
    s_nop 0
    buffer_load_dwordx4 v72, s[16:19], s46 offen offset:0  lds
    buffer_load_dwordx4 v73, s[16:19], s46 offen offset:1024  lds
    buffer_load_dwordx4 v74, s[16:19], s46 offen offset:2048  lds
    buffer_load_dwordx4 v75, s[16:19], s46 offen offset:3072  lds
    s_add_u32 m0, s47, 36864
    s_nop 0
    buffer_load_dwordx4 v76, s[16:19], s46 offen offset:0  lds
    buffer_load_dwordx4 v77, s[16:19], s46 offen offset:1024  lds
    buffer_load_dwordx4 v78, s[16:19], s46 offen offset:2048  lds
    buffer_load_dwordx4 v79, s[16:19], s46 offen offset:3072  lds
    s_add_u32 s53, s37, 3
    s_and_b32 s53, s53, 3
    s_and_b32 s44, s37, 4
    s_or_b32 s53, s53, s44
    s_lshl_b32 s53, s53, 1
    s_add_u32 s53, s53, 1
    s_add_u32 s56, s55, 112640
    s_lshr_b32 s99, s53, 1
    s_bitcmp1_b32 s90, s99
    s_cbranch_scc1 L_36
    s_movk_i32 s91, 1024
    s_mov_b32 s92, 112640
    s_getpc_b64 s[94:95]
L_37:
    s_add_u32 s94, s94, L_slow-L_37
    s_addc_u32 s95, s95, 0
    s_swappc_b64 s[96:97], s[94:95]
L_36:
    s_mul_i32 s54, s53, 14336
    s_mov_b32 m0, s56
    s_add_u32 s54, s54, s57
    buffer_load_dwordx4 v80, s[4:7], s54 offen offset:0 sc1 lds
    buffer_load_dwordx4 v80, s[4:7], s54 offen offset:1024 sc1 lds
    buffer_load_dwordx4 v80, s[4:7], s54 offen offset:2048 sc1 lds
    s_cmp_ge_u32 s39, 2
    s_cbranch_scc1 L_38
    buffer_load_dwordx4 v80, s[4:7], s54 offen offset:3072 sc1 lds
L_38:
    s_waitcnt vmcnt(14)
    s_waitcnt vmcnt(11)
    s_barrier
    s_add_u32 s53, s37, 2
    s_and_b32 s53, s53, 3
    s_andn2_b32 s44, 4, s37
    s_or_b32 s53, s53, s44
    s_lshl_b32 s53, s53, 1
    s_add_u32 s53, s53, 1
    s_lshl_b32 s46, s53, 7
    s_add_u32 m0, s47, 65536
    s_nop 0
    buffer_load_dwordx4 v72, s[16:19], s46 offen offset:0  lds
    buffer_load_dwordx4 v73, s[16:19], s46 offen offset:1024  lds
    buffer_load_dwordx4 v74, s[16:19], s46 offen offset:2048  lds
    buffer_load_dwordx4 v75, s[16:19], s46 offen offset:3072  lds
    s_add_u32 m0, s47, 69632
    s_nop 0
    buffer_load_dwordx4 v76, s[16:19], s46 offen offset:0  lds
    buffer_load_dwordx4 v77, s[16:19], s46 offen offset:1024  lds
    buffer_load_dwordx4 v78, s[16:19], s46 offen offset:2048  lds
    buffer_load_dwordx4 v79, s[16:19], s46 offen offset:3072  lds
    s_add_u32 s53, s37, 2
    s_and_b32 s53, s53, 3
    s_andn2_b32 s44, 4, s37
    s_or_b32 s53, s53, s44
    s_lshl_b32 s53, s53, 1
    s_add_u32 s53, s53, 1
    s_add_u32 s56, s55, 126976
    s_lshr_b32 s99, s53, 1
    s_bitcmp1_b32 s90, s99
    s_cbranch_scc1 L_39
    s_movk_i32 s91, 1024
    s_mov_b32 s92, 126976
    s_getpc_b64 s[94:95]
L_40:
    s_add_u32 s94, s94, L_slow-L_40
    s_addc_u32 s95, s95, 0
    s_swappc_b64 s[96:97], s[94:95]
L_39:
    s_mul_i32 s54, s53, 14336
    s_mov_b32 m0, s56
    s_add_u32 s54, s54, s57
    buffer_load_dwordx4 v80, s[4:7], s54 offen offset:0 sc1 lds
    buffer_load_dwordx4 v80, s[4:7], s54 offen offset:1024 sc1 lds
    buffer_load_dwordx4 v80, s[4:7], s54 offen offset:2048 sc1 lds
    s_cmp_ge_u32 s39, 2
    s_cbranch_scc1 L_41
    buffer_load_dwordx4 v80, s[4:7], s54 offen offset:3072 sc1 lds
L_41:
    s_waitcnt vmcnt(14)
    s_waitcnt vmcnt(11)
    s_barrier
    s_add_u32 s53, s37, 3
    s_and_b32 s53, s53, 3
    s_andn2_b32 s44, 4, s37
    s_or_b32 s53, s53, s44
    s_lshl_b32 s53, s53, 1
    s_add_u32 s53, s53, 1
    s_lshl_b32 s46, s53, 7
    s_add_u32 m0, s47, 0
    s_nop 0
    buffer_load_dwordx4 v72, s[16:19], s46 offen offset:0  lds
    buffer_load_dwordx4 v73, s[16:19], s46 offen offset:1024  lds
    buffer_load_dwordx4 v74, s[16:19], s46 offen offset:2048  lds
    buffer_load_dwordx4 v75, s[16:19], s46 offen offset:3072  lds
    s_add_u32 m0, s47, 4096
    s_nop 0
    buffer_load_dwordx4 v76, s[16:19], s46 offen offset:0  lds
    buffer_load_dwordx4 v77, s[16:19], s46 offen offset:1024  lds
    buffer_load_dwordx4 v78, s[16:19], s46 offen offset:2048  lds
    buffer_load_dwordx4 v79, s[16:19], s46 offen offset:3072  lds
    s_add_u32 s53, s37, 3
    s_and_b32 s53, s53, 3
    s_andn2_b32 s44, 4, s37
    s_or_b32 s53, s53, s44
    s_lshl_b32 s53, s53, 1
    s_add_u32 s53, s53, 1
    s_add_u32 s56, s55, 98304
    s_lshr_b32 s99, s53, 1
    s_bitcmp1_b32 s90, s99
    s_cbranch_scc1 L_42
    s_movk_i32 s91, 1024
    s_mov_b32 s92, 98304
    s_getpc_b64 s[94:95]
L_43:
    s_add_u32 s94, s94, L_slow-L_43
    s_addc_u32 s95, s95, 0
    s_swappc_b64 s[96:97], s[94:95]
L_42:
    s_mul_i32 s54, s53, 14336
    s_mov_b32 m0, s56
    s_add_u32 s54, s54, s57
    buffer_load_dwordx4 v80, s[4:7], s54 offen offset:0 sc1 lds
    buffer_load_dwordx4 v80, s[4:7], s54 offen offset:1024 sc1 lds
    buffer_load_dwordx4 v80, s[4:7], s54 offen offset:2048 sc1 lds
    s_cmp_ge_u32 s39, 2
    s_cbranch_scc1 L_44
    buffer_load_dwordx4 v80, s[4:7], s54 offen offset:3072 sc1 lds
L_44:
    s_waitcnt vmcnt(14)
    s_waitcnt vmcnt(11)
    s_barrier
    s_waitcnt vmcnt(3)
    s_waitcnt vmcnt(0)
    s_barrier
    s_cmp_lg_u32 s39, 0
    s_cbranch_scc1 L_45
    s_lshl_b32 s44, s36, 7
    s_lshl_b32 s45, s37, 2
    s_add_u32 s44, s44, s45
    s_add_u32 s44, s44, 7471104
    s_add_u32 s45, s52, 1
    v_mov_b32 v5, s44
    v_mov_b32 v6, s45
    s_mov_b64 exec, 1
    buffer_store_dword v6, v5, s[4:7], 0 offen sc1
    s_mov_b64 exec, -1
L_45:
    s_endpgm
L_slow:
    s_cmp_lg_u32 s59, 0
    s_cselect_b32 s88, 1, 4096
    s_lshl_b32 s93, 1, s99
L_48:
    s_mov_b32 exec_hi, 0
    s_mov_b32 exec_lo, s93
    buffer_load_dwordx2 v[88:89], v86, s[4:7], s91 offen sc1
    s_waitcnt vmcnt(0)
    v_cmp_ne_u32 vcc, v88, v85
    v_cmp_ne_u32 s[44:45], v89, v85
    s_mov_b64 exec, -1
    s_nop 0
    s_or_b32 s44, s44, vcc_lo
    s_cbranch_scc0 L_46
    s_sub_u32 s88, s88, 1
    s_cmp_lg_u32 s88, 0
    s_cbranch_scc1 L_48
    s_add_u32 s59, s59, 1
    s_mul_i32 s41, s53, 7168
    s_lshl_b32 s40, s53, 2
    s_mul_i32 s40, s40, 16*14336
    s_mul_i32 s45, s51, 3584
    s_add_u32 s45, s45, 112640
    s_sub_u32 s92, s92, s45
    s_movk_i32 s88, 4
L_47:
    buffer_load_dwordx2 v[228:229], v4, s[24:27], s41 offen
    buffer_load_dwordx2 v[230:231], v4, s[28:31], s41 offen
    buffer_load_dwordx4 v[196:199], v16, s[20:23], s40 offen
    buffer_load_dwordx4 v[200:203], v17, s[20:23], s40 offen
    buffer_load_dwordx4 v[204:207], v18, s[20:23], s40 offen
    buffer_load_dwordx4 v[208:211], v19, s[20:23], s40 offen
    buffer_load_dwordx4 v[212:215], v20, s[20:23], s40 offen
    buffer_load_dwordx4 v[216:219], v21, s[20:23], s40 offen
    buffer_load_dwordx4 v[220:223], v22, s[20:23], s40 offen
    buffer_load_dwordx4 v[224:227], v23, s[20:23], s40 offen
    s_waitcnt vmcnt(8)
    v_lshlrev_b32 v28, 16, v228
    v_and_b32 v29, 0xffff0000, v228
    v_lshlrev_b32 v30, 16, v229
    v_and_b32 v31, 0xffff0000, v229
    v_lshlrev_b32 v36, 16, v230
    v_and_b32 v37, 0xffff0000, v230
    v_lshlrev_b32 v38, 16, v231
    v_and_b32 v39, 0xffff0000, v231
    v_mul_f32_e64 v32, -v36, v28
    v_mul_f32_e64 v33, -v37, v29
    v_mul_f32_e64 v34, -v38, v30
    v_mul_f32_e64 v35, -v39, v31
    s_waitcnt vmcnt(0)
    v_cvt_f32_i32 v52, v196
    v_cvt_f32_i32 v53, v200
    v_cvt_f32_i32 v54, v204
    v_cvt_f32_i32 v55, v208
    v_cvt_f32_i32 v56, v212
    v_cvt_f32_i32 v57, v216
    v_cvt_f32_i32 v58, v220
    v_cvt_f32_i32 v59, v224
    v_fma_f32 v52, v52, v28, v32
    v_fma_f32 v53, v53, v28, v32
    v_fma_f32 v54, v54, v28, v32
    v_fma_f32 v55, v55, v28, v32
    v_fma_f32 v56, v56, v28, v32
    v_fma_f32 v57, v57, v28, v32
    v_fma_f32 v58, v58, v28, v32
    v_fma_f32 v59, v59, v28, v32
    v_cvt_pk_bf16_f32 v44, v52, v53
    v_cvt_pk_bf16_f32 v45, v54, v55
    v_cvt_pk_bf16_f32 v46, v56, v57
    v_cvt_pk_bf16_f32 v47, v58, v59
    v_add_u32 v6, s92, v40
    ds_write_b128 v6, v[44:47]
    v_cvt_f32_i32 v60, v197
    v_cvt_f32_i32 v61, v201
    v_cvt_f32_i32 v62, v205
    v_cvt_f32_i32 v63, v209
    v_cvt_f32_i32 v64, v213
    v_cvt_f32_i32 v65, v217
    v_cvt_f32_i32 v66, v221
    v_cvt_f32_i32 v67, v225
    v_fma_f32 v60, v60, v29, v33
    v_fma_f32 v61, v61, v29, v33
    v_fma_f32 v62, v62, v29, v33
    v_fma_f32 v63, v63, v29, v33
    v_fma_f32 v64, v64, v29, v33
    v_fma_f32 v65, v65, v29, v33
    v_fma_f32 v66, v66, v29, v33
    v_fma_f32 v67, v67, v29, v33
    v_cvt_pk_bf16_f32 v48, v60, v61
    v_cvt_pk_bf16_f32 v49, v62, v63
    v_cvt_pk_bf16_f32 v50, v64, v65
    v_cvt_pk_bf16_f32 v51, v66, v67
    v_add_u32 v6, s92, v41
    ds_write_b128 v6, v[48:51]
    v_cvt_f32_i32 v52, v198
    v_cvt_f32_i32 v53, v202
    v_cvt_f32_i32 v54, v206
    v_cvt_f32_i32 v55, v210
    v_cvt_f32_i32 v56, v214
    v_cvt_f32_i32 v57, v218
    v_cvt_f32_i32 v58, v222
    v_cvt_f32_i32 v59, v226
    v_fma_f32 v52, v52, v30, v34
    v_fma_f32 v53, v53, v30, v34
    v_fma_f32 v54, v54, v30, v34
    v_fma_f32 v55, v55, v30, v34
    v_fma_f32 v56, v56, v30, v34
    v_fma_f32 v57, v57, v30, v34
    v_fma_f32 v58, v58, v30, v34
    v_fma_f32 v59, v59, v30, v34
    v_cvt_pk_bf16_f32 v44, v52, v53
    v_cvt_pk_bf16_f32 v45, v54, v55
    v_cvt_pk_bf16_f32 v46, v56, v57
    v_cvt_pk_bf16_f32 v47, v58, v59
    v_add_u32 v6, s92, v42
    ds_write_b128 v6, v[44:47]
    v_cvt_f32_i32 v60, v199
    v_cvt_f32_i32 v61, v203
    v_cvt_f32_i32 v62, v207
    v_cvt_f32_i32 v63, v211
    v_cvt_f32_i32 v64, v215
    v_cvt_f32_i32 v65, v219
    v_cvt_f32_i32 v66, v223
    v_cvt_f32_i32 v67, v227
    v_fma_f32 v60, v60, v31, v35
    v_fma_f32 v61, v61, v31, v35
    v_fma_f32 v62, v62, v31, v35
    v_fma_f32 v63, v63, v31, v35
    v_fma_f32 v64, v64, v31, v35
    v_fma_f32 v65, v65, v31, v35
    v_fma_f32 v66, v66, v31, v35
    v_fma_f32 v67, v67, v31, v35
    v_cvt_pk_bf16_f32 v48, v60, v61
    v_cvt_pk_bf16_f32 v49, v62, v63
    v_cvt_pk_bf16_f32 v50, v64, v65
    v_cvt_pk_bf16_f32 v51, v66, v67
    v_add_u32 v6, s92, v43
    ds_write_b128 v6, v[48:51]
    s_waitcnt lgkmcnt(0)
    s_add_u32 s40, s40, 229376
    s_add_u32 s92, s92, 3584
    s_sub_u32 s88, s88, 1
    s_cmp_lg_u32 s88, 0
    s_cbranch_scc1 L_47
    s_mov_b32 s56, 141312
L_46:
    s_setpc_b64 s[96:97]
L_end:
    s_endpgm
.section .rodata,"a"
.p2align 6
.amdhsa_kernel standalone__weight_only_int_quip_2__prompt_kernel
  .amdhsa_next_free_vgpr 256
  .amdhsa_next_free_sgpr 102
  .amdhsa_accum_offset 256
  .amdhsa_group_segment_fixed_size 0
  .amdhsa_kernarg_size 56
  .amdhsa_user_sgpr_count 2
  .amdhsa_user_sgpr_kernarg_segment_ptr 1
  .amdhsa_system_sgpr_workgroup_id_x 1
  .amdhsa_float_denorm_mode_32 3
.end_amdhsa_kernel
```
